```python
import torch

def _softmax(x, axis=-1):
    return torch.softmax(x, dim=axis)
def _gelu(x):
    return torch.nn.functional.gelu(x, approximate="tanh")
def _silu(x):
    return torch.nn.functional.silu(x)
def _sigmoid(x):
    return torch.sigmoid(x)
def _layernorm(x, axis=-1, eps=1e-5):
    m = x.mean(dim=axis, keepdim=True)
    v = x.var(dim=axis, keepdim=True, unbiased=False)
    return (x - m) / torch.sqrt(v + eps)
def _scatter_add(tgt, idx, src, axis=0):
    return tgt.clone().index_add_(axis, idx, src)
def _segment_sum(src, seg, n):
    out = torch.zeros((n,) + src.shape[1:], dtype=src.dtype)
    return out.index_add_(0, seg, src)
def _pad(x, pw):
    flat = tuple(v for pair in reversed(pw) for v in pair)
    return torch.nn.functional.pad(x, flat)

kernel_name = 'concat_heads__sliding_block_cached__mha_block_cached__decode'

def setup_inputs():

    _w = (lambda a: (lambda t: t.to(torch.bfloat16) if t.is_floating_point() else t)(torch.as_tensor(a)))
    def _A_setup():
        B, Sq, D = 2, 1, 576
        Hq, Hkv, Sk, Dh = 32, 16, 8192, 128
        assert Hq % Hkv == 0, (Hq, Hkv)
        return {
            "x": _w((lambda *s: torch.randn(*s, dtype=torch.bfloat16) * 0.8)(B, Sq, D)),
            "k_cache": _w((lambda *s: torch.randn(*s, dtype=torch.bfloat16) * 1.6)(B, Hkv, Sk, Dh)),
            "v_cache": _w((lambda *s: torch.randn(*s, dtype=torch.bfloat16) * 0.2)(B, Hkv, Sk, Dh)),
            "wq": _w((lambda *s: torch.randn(*s, dtype=torch.bfloat16) * 1.6)(D, Hq * Dh) * (D ** -0.5)),
            "wo": _w((lambda *s: torch.randn(*s, dtype=torch.bfloat16) * 0.2)(Hq * Dh, D) * ((Hq * Dh) ** -0.5)),
        }
    _A_in = _A_setup()

    def _B_setup():
        B, Sq, D = 2, 1, 576
        H, Sk, Dh = 32, 8192, 128
        return {
            "x": _w((lambda *s: torch.randn(*s, dtype=torch.bfloat16) * 0.8)(B, Sq, D)),
            "k_cache": _w((lambda *s: torch.randn(*s, dtype=torch.bfloat16) * 1.6)(B, H, Sk, Dh)),
            "v_cache": _w((lambda *s: torch.randn(*s, dtype=torch.bfloat16) * 0.2)(B, H, Sk, Dh)),
            "wq": _w((lambda *s: torch.randn(*s, dtype=torch.bfloat16) * 1.6)(D, H * Dh) * (D ** -0.5)),
            "wo": _w((lambda *s: torch.randn(*s, dtype=torch.bfloat16) * 0.2)(H * Dh, D) * ((H * Dh) ** -0.5)),
        }
    _B_in = _B_setup()

    return {
        "A_x": _A_in["x"],
        "A_k_cache": _A_in["k_cache"],
        "A_v_cache": _A_in["v_cache"],
        "A_wq": _A_in["wq"],
        "A_wo": _A_in["wo"],
        "B_x": _B_in["x"],
        "B_k_cache": _B_in["k_cache"],
        "B_v_cache": _B_in["v_cache"],
        "B_wq": _B_in["wq"],
        "B_wo": _B_in["wo"],
    }

def reference(A_x, A_k_cache, A_v_cache, A_wq, A_wo, B_x, B_k_cache, B_v_cache, B_wq, B_wo):
    def _A_ref(x, k_cache, v_cache, wq, wo):
        B, Sq, D = x.shape
        Hq, Dh = 32, 128
        Hkv, Sk = k_cache.shape[1], k_cache.shape[2]
        W = min(4096, max(256, Sk // 4))
        rep = Hq // Hkv
        q = (lambda x, *d: x.permute(*d))((x @ wq).reshape(B, Sq, Hq, Dh), 0, 2, 1, 3)
        k = (lambda x, n, axis: torch.repeat_interleave(x, n, dim=axis))(k_cache[:, :, Sk - W:, :], rep, axis=1)
        v = (lambda x, n, axis: torch.repeat_interleave(x, n, dim=axis))(v_cache[:, :, Sk - W:, :], rep, axis=1)
        scores = torch.einsum("bhqd,bhkd->bhqk", q, k) * (Dh ** -0.5)
        p = _softmax(scores, axis=-1)
        o = torch.einsum("bhqk,bhkd->bhqd", p, v)
        return (lambda x, *d: x.permute(*d))(o, 0, 2, 1, 3).reshape(B, Sq, Hq * Dh) @ wo

    def _B_ref(x, k_cache, v_cache, wq, wo):
        B, Sq, D = x.shape
        H, Dh = 32, 128
        q = (lambda x, *d: x.permute(*d))((x @ wq).reshape(B, Sq, H, Dh), 0, 2, 1, 3)
        scores = torch.einsum("bhqd,bhkd->bhqk", q, k_cache) * (Dh ** -0.5)
        p = _softmax(scores, axis=-1)
        o = torch.einsum("bhqk,bhkd->bhqd", p, v_cache)
        return (lambda x, *d: x.permute(*d))(o, 0, 2, 1, 3).reshape(B, Sq, H * Dh) @ wo

    a = _A_ref(A_x, A_k_cache, A_v_cache, A_wq, A_wo)
    b = _B_ref(B_x, B_k_cache, B_v_cache, B_wq, B_wo)
    return torch.concatenate([a, b], axis=-1)
```

```asm
; @launch grid=(256,1,1) block=(512,1,1) lds=28672
.amdgcn_target "amdgcn-amd-amdhsa--gfx950"
.text
.globl concat_heads__sliding_block_cached__mha_block_cached__decode_kernel
.p2align 12
.type concat_heads__sliding_block_cached__mha_block_cached__decode_kernel,@function
concat_heads__sliding_block_cached__mha_block_cached__decode_kernel:
    s_cmp_ge_u32 s2, 256
    s_cbranch_scc1 L_end
    s_load_dwordx16 s[4:19], s[0:1], 0
    s_load_dwordx8 s[20:27], s[0:1], 64
    s_load_dwordx2 s[28:29], s[0:1], 96
    s_memrealtime s[72:73]
    v_lshrrev_b32 v2, 6, v0
    v_and_b32 v1, 63, v0
    v_readfirstlane_b32 s3, v2
    v_lshlrev_b32 v0, 4, v1
    s_and_b32 s59, s2, 7
    s_lshr_b32 s60, s2, 3
    s_bfe_u32 s66, s2, 0x10000
    s_lshl_b32 s48, s66, 15
    s_bfe_u32 s66, s2, 0x20001
    s_lshl_b32 s66, s66, 22
    s_add_u32 s48, s48, s66
    s_bfe_u32 s66, s2, 0x20003
    s_lshl_b32 s66, s66, 20
    s_add_u32 s48, s48, s66
    s_bfe_u32 s66, s2, 0x30005
    s_lshl_b32 s66, s66, 24
    s_add_u32 s48, s48, s66
    s_lshr_b32 s61, s48, 21
    s_lshl_b32 s61, s61, 2
    s_bfe_u32 s66, s48, 0x1000f
    s_lshl_b32 s66, s66, 1
    s_add_u32 s61, s61, s66
    s_bfe_u32 s66, s48, 0x10014
    s_add_u32 s61, s61, s66
    s_mov_b32 s77, 16
    s_bfe_u32 s31, s61, 0x50002
    s_lshr_b32 s51, s61, 7
    v_add_u32 v42, 0x10000, v0
    s_mov_b32 s34, 134217728
    s_mov_b32 s35, 0x20000
    s_mov_b32 s38, 134217728
    s_mov_b32 s39, 0x20000
    v_mov_b32 v3, 0
    s_mov_b32 s42, 2097152
    s_mov_b32 s43, 0x20000
    s_cmp_eq_u32 s3, 0
    s_cbranch_scc1 L_w0
    s_sub_u32 s68, s3, 1
    s_bfe_u32 s66, s68, 0x20000
    s_lshl_b32 s66, s66, 12
    s_add_u32 s78, s48, s66
    s_bfe_u32 s66, s68, 0x10002
    s_lshl_b32 s66, s66, 18
    s_add_u32 s78, s78, s66
    s_bfe_u32 s66, s68, 0x10003
    s_lshl_b32 s66, s66, 17
    s_add_u32 s78, s78, s66
    s_bfe_u32 s66, s68, 0x10004
    s_lshl_b32 s66, s66, 19
    s_add_u32 s78, s78, s66
    s_bfe_u32 s66, s68, 0x10005
    s_lshl_b32 s66, s66, 14
    s_add_u32 s78, s78, s66
    s_add_u32 s68, s68, 7
    s_bfe_u32 s66, s68, 0x20000
    s_lshl_b32 s66, s66, 12
    s_add_u32 s79, s48, s66
    s_bfe_u32 s66, s68, 0x10002
    s_lshl_b32 s66, s66, 18
    s_add_u32 s79, s79, s66
    s_bfe_u32 s66, s68, 0x10003
    s_lshl_b32 s66, s66, 17
    s_add_u32 s79, s79, s66
    s_bfe_u32 s66, s68, 0x10004
    s_lshl_b32 s66, s66, 19
    s_add_u32 s79, s79, s66
    s_bfe_u32 s66, s68, 0x10005
    s_lshl_b32 s66, s66, 14
    s_add_u32 s79, s79, s66
    s_add_u32 s68, s68, 7
    s_bfe_u32 s66, s68, 0x20000
    s_lshl_b32 s66, s66, 12
    s_add_u32 s30, s48, s66
    s_bfe_u32 s66, s68, 0x10002
    s_lshl_b32 s66, s66, 18
    s_add_u32 s30, s30, s66
    s_bfe_u32 s66, s68, 0x10003
    s_lshl_b32 s66, s66, 17
    s_add_u32 s30, s30, s66
    s_bfe_u32 s66, s68, 0x10004
    s_lshl_b32 s66, s66, 19
    s_add_u32 s30, s30, s66
    s_bfe_u32 s66, s68, 0x10005
    s_lshl_b32 s66, s66, 14
    s_add_u32 s30, s30, s66
    s_add_u32 s68, s68, 7
    s_bfe_u32 s66, s68, 0x20000
    s_lshl_b32 s66, s66, 12
    s_add_u32 s50, s48, s66
    s_bfe_u32 s66, s68, 0x10002
    s_lshl_b32 s66, s66, 18
    s_add_u32 s50, s50, s66
    s_bfe_u32 s66, s68, 0x10003
    s_lshl_b32 s66, s66, 17
    s_add_u32 s50, s50, s66
    s_bfe_u32 s66, s68, 0x10004
    s_lshl_b32 s66, s66, 19
    s_add_u32 s50, s50, s66
    s_bfe_u32 s66, s68, 0x10005
    s_lshl_b32 s66, s66, 14
    s_add_u32 s50, s50, s66
    s_add_u32 s68, s68, 7
    s_mov_b32 s53, s68
    s_waitcnt lgkmcnt(0)
    s_mov_b32 s32, s16
    s_mov_b32 s33, s17
    s_mov_b32 s36, s16
    s_mov_b32 s37, s17
    s_mov_b32 s40, s28
    s_mov_b32 s41, s29
    buffer_load_dwordx4 v[96:99], v0, s[32:35], s78 offen offset:0 nt
    buffer_load_dwordx4 v[100:103], v0, s[32:35], s78 offen offset:1024 nt
    buffer_load_dwordx4 v[104:107], v0, s[32:35], s78 offen offset:2048 nt
    buffer_load_dwordx4 v[108:111], v0, s[32:35], s78 offen offset:3072 nt
    s_barrier
L_pq_j:
    buffer_load_dwordx4 v[112:115], v42, s[36:39], s78 offen offset:0 nt
    buffer_load_dwordx4 v[116:119], v42, s[36:39], s78 offen offset:1024 nt
    buffer_load_dwordx4 v[120:123], v42, s[36:39], s78 offen offset:2048 nt
    buffer_load_dwordx4 v[124:127], v42, s[36:39], s78 offen offset:3072 nt
    s_waitcnt vmcnt(7)
    buffer_load_dwordx4 v[128:131], v0, s[32:35], s79 offen offset:0 nt
    s_waitcnt vmcnt(7)
    buffer_load_dwordx4 v[132:135], v0, s[32:35], s79 offen offset:1024 nt
    s_waitcnt vmcnt(7)
    buffer_load_dwordx4 v[136:139], v0, s[32:35], s79 offen offset:2048 nt
    s_waitcnt vmcnt(7)
    buffer_load_dwordx4 v[140:143], v0, s[32:35], s79 offen offset:3072 nt
    s_waitcnt vmcnt(7)
    buffer_load_dwordx4 v[144:147], v42, s[36:39], s79 offen offset:0 nt
    s_waitcnt vmcnt(7)
    buffer_load_dwordx4 v[148:151], v42, s[36:39], s79 offen offset:1024 nt
    s_waitcnt vmcnt(7)
    buffer_load_dwordx4 v[152:155], v42, s[36:39], s79 offen offset:2048 nt
    s_waitcnt vmcnt(7)
    buffer_load_dwordx4 v[156:159], v42, s[36:39], s79 offen offset:3072 nt
    s_waitcnt vmcnt(7)
    buffer_load_dwordx4 v[160:163], v0, s[32:35], s30 offen offset:0 nt
    s_waitcnt vmcnt(7)
    buffer_load_dwordx4 v[164:167], v0, s[32:35], s30 offen offset:1024 nt
    s_waitcnt vmcnt(7)
    buffer_load_dwordx4 v[168:171], v0, s[32:35], s30 offen offset:2048 nt
    s_waitcnt vmcnt(7)
    buffer_load_dwordx4 v[172:175], v0, s[32:35], s30 offen offset:3072 nt
    s_waitcnt vmcnt(7)
    buffer_load_dwordx4 v[176:179], v42, s[36:39], s30 offen offset:0 nt
    s_waitcnt vmcnt(7)
    buffer_load_dwordx4 v[180:183], v42, s[36:39], s30 offen offset:1024 nt
    s_waitcnt vmcnt(7)
    buffer_load_dwordx4 v[184:187], v42, s[36:39], s30 offen offset:2048 nt
    s_waitcnt vmcnt(7)
    buffer_load_dwordx4 v[188:191], v42, s[36:39], s30 offen offset:3072 nt
    s_waitcnt vmcnt(7)
    buffer_load_dwordx4 v[64:67], v0, s[32:35], s50 offen offset:0 nt
    s_waitcnt vmcnt(7)
    buffer_load_dwordx4 v[68:71], v0, s[32:35], s50 offen offset:1024 nt
    s_waitcnt vmcnt(7)
    buffer_load_dwordx4 v[72:75], v0, s[32:35], s50 offen offset:2048 nt
    s_waitcnt vmcnt(7)
    buffer_load_dwordx4 v[76:79], v0, s[32:35], s50 offen offset:3072 nt
    s_waitcnt vmcnt(7)
    buffer_load_dwordx4 v[80:83], v42, s[36:39], s50 offen offset:0 nt
    s_waitcnt vmcnt(7)
    buffer_load_dwordx4 v[84:87], v42, s[36:39], s50 offen offset:1024 nt
    s_waitcnt vmcnt(7)
    buffer_load_dwordx4 v[88:91], v42, s[36:39], s50 offen offset:2048 nt
    s_waitcnt vmcnt(7)
    buffer_load_dwordx4 v[92:95], v42, s[36:39], s50 offen offset:3072 nt
    s_mov_b32 s62, 0
    s_mov_b32 s63, 0
    s_mov_b32 s64, 0
    s_mov_b32 s66, s2
    s_cmp_lt_u32 s2, 144
    s_cbranch_scc0 L_consd0
L_cons0:
    s_lshr_b32 s63, s66, 3
    s_and_b32 s64, s66, 7
    s_mov_b32 s62, 1
    s_cmp_lt_u32 s63, 9
    s_cbranch_scc1 L_consd0
    s_mov_b32 s62, 2
L_consd0:
    s_mul_i32 s66, s60, 256
    s_add_u32 s66, s66, 0x20000
    v_mov_b32 v2, s66
    v_mov_b32 v4, 1
    s_lshl_b32 s49, s60, 21
    s_add_u32 s49, s49, 1572864
    s_mov_b32 s58, 0x3e0293ee
    s_add_u32 s72, s72, 0x64
    s_bitcmp1_b32 s59, 0
    s_mov_b32 s74, 7160
    s_cselect_b32 s74, 7160, s74
    s_lshl_b32 s66, s66, 7
    s_mul_i32 s67, s64, 589824
    s_add_u32 s66, s66, s67
    s_mul_i32 s67, s3, 73728
    s_add_u32 s65, s66, s67
    s_add_u32 s71, s65, 4608
    v_lshrrev_b32 v7, 3, v1
    v_mul_u32_u24 v7, 9216, v7
    v_and_b32 v6, 7, v1
    v_lshl_add_u32 v7, v6, 4, v7
    s_lshl_b32 s26, s77, 2
    s_lshl_b32 s27, s77, 3
    s_mov_b32 s52, 0
    s_mov_b32 s54, 0
    v_lshrrev_b32 v251, 4, v1
    v_lshlrev_b32 v251, 5, v251
    v_add_u32 v251, 0x4d00, v251
    v_and_b32 v43, 12, v1
    v_add_u32 v43, v43, v251
    v_mov_b32 v20, 0
    v_mov_b32 v21, 0
    v_mov_b32 v22, 0
    v_mov_b32 v23, 0
    v_mov_b32 v24, 0
    v_mov_b32 v25, 0
    v_mov_b32 v26, 0
    v_mov_b32 v27, 0
    v_mov_b32 v28, 0
    v_mov_b32 v29, 0
    v_mov_b32 v30, 0
    v_mov_b32 v31, 0
    v_mov_b32 v32, 0
    v_mov_b32 v33, 0
    v_mov_b32 v34, 0
    v_mov_b32 v35, 0
    v_mov_b32 v36, 0xff61b1e6
    v_mul_f32 v38, s58, v36
    v_mov_b32 v40, 0
    v_mov_b32 v37, 0xff61b1e6
    v_mul_f32 v39, s58, v37
    v_mov_b32 v41, 0
    s_mov_b32 s70, 0
L_qfw:
    ds_read_b64 v[44:45], v3 offset:16
    s_waitcnt lgkmcnt(0)
    v_readfirstlane_b32 s66, v44
    v_readfirstlane_b32 s56, v45
    s_nop 3
    s_cmp_eq_u32 s66, 1
    s_cbranch_scc1 L_qfok
    s_add_u32 s70, s70, 1
    s_cmp_lt_u32 s70, 1600000
    s_cbranch_scc0 L_qfok
    s_sleep 2
    s_branch L_qfw
L_qfok:
    v_and_b32 v44, 0xf0, v0
    ds_read_b128 v[8:11], v44 offset:19456
    s_waitcnt lgkmcnt(0)
    s_branch L_peel
L_w0:
    s_setprio 3
    s_and_b32 s68, s61, 3
    s_lshl_b32 s69, s51, 2
    s_add_u32 s69, s69, s68
    v_lshrrev_b32 v44, 4, v1
    v_mul_u32_u24 v228, 147456, v44
    v_and_b32 v45, 0xf0, v0
    s_mul_i32 s66, s69, 589824
    s_lshl_b32 s67, s31, 8
    s_add_u32 s66, s66, s67
    v_add3_u32 v228, v228, v45, s66
    v_add_u32 v229, 0x2000, v228
    v_bfe_u32 v45, v1, 3, 1
    v_mul_u32_u24 v45, 1152, v45
    v_mul_u32_u24 v230, 36, v44
    s_mul_i32 s66, s69, 144
    v_add3_u32 v230, v230, v45, s66
    s_sub_u32 s66, s60, s31
    s_lshl_b32 s66, s66, 8
    s_sub_u32 s67, s59, s69
    s_mul_i32 s68, s67, 589824
    s_add_u32 s66, s66, s68
    s_mul_i32 s67, s67, 144
    v_add_u32 v231, s66, v228
    v_add_u32 v232, s66, v229
    v_add_u32 v233, s67, v230
    s_mov_b32 s82, 4718592
    s_mov_b32 s83, 0x20000
    s_mov_b32 s46, 2304
    s_mov_b32 s47, 0x20000
    v_mov_b32 v48, 29
    v_mov_b32 v49, 0
    v_mov_b32 v50, 0
    v_mov_b32 v51, 0
    s_mov_b64 exec, 1
    ds_write_b128 v3, v[48:51]
    ds_write_b32 v3, v3 offset:16
    ds_write2_b64 v3, v[50:51], v[50:51] offset0:4 offset1:5
    v_mov_b32 v52, 0xff61b1e6
    ds_write_b32 v3, v52 offset:24
    ds_write_b32 v3, v3 offset:28
    ds_write_b64 v3, v[50:51] offset:48
    s_mov_b64 exec, -1
    s_waitcnt lgkmcnt(0)
    s_mov_b32 s80, s20
    s_mov_b32 s81, s21
    s_mov_b32 s44, s14
    s_mov_b32 s45, s15
    buffer_load_dwordx4 v[208:211], v230, s[44:47], 0 offen
    buffer_load_dwordx4 v[212:215], v230, s[44:47], 0 offen offset:16
    buffer_load_dword v216, v230, s[44:47], 0 offen offset:32
    s_mov_b32 s66, 0
    buffer_load_dwordx4 v[64:67], v228, s[80:83], s66 offen nt
    buffer_load_dwordx4 v[68:71], v229, s[80:83], s66 offen nt
    s_mov_b32 s66, 16384
    buffer_load_dwordx4 v[72:75], v228, s[80:83], s66 offen nt
    buffer_load_dwordx4 v[76:79], v229, s[80:83], s66 offen nt
    s_mov_b32 s66, 32768
    buffer_load_dwordx4 v[80:83], v228, s[80:83], s66 offen nt
    buffer_load_dwordx4 v[84:87], v229, s[80:83], s66 offen nt
    s_mov_b32 s66, 49152
    buffer_load_dwordx4 v[88:91], v228, s[80:83], s66 offen nt
    buffer_load_dwordx4 v[92:95], v229, s[80:83], s66 offen nt
    s_mov_b32 s66, 65536
    buffer_load_dwordx4 v[96:99], v228, s[80:83], s66 offen nt
    buffer_load_dwordx4 v[100:103], v229, s[80:83], s66 offen nt
    s_mov_b32 s66, 81920
    buffer_load_dwordx4 v[104:107], v228, s[80:83], s66 offen nt
    buffer_load_dwordx4 v[108:111], v229, s[80:83], s66 offen nt
    s_mov_b32 s66, 98304
    buffer_load_dwordx4 v[112:115], v228, s[80:83], s66 offen nt
    buffer_load_dwordx4 v[116:119], v229, s[80:83], s66 offen nt
    s_mov_b32 s66, 114688
    buffer_load_dwordx4 v[120:123], v228, s[80:83], s66 offen nt
    buffer_load_dwordx4 v[124:127], v229, s[80:83], s66 offen nt
    s_mov_b32 s66, 131072
    buffer_load_dwordx4 v[128:131], v228, s[80:83], s66 offen nt
    buffer_load_dwordx4 v[132:135], v229, s[80:83], s66 offen nt
    s_mov_b32 s32, s16
    s_mov_b32 s33, s17
    s_mov_b32 s36, s16
    s_mov_b32 s37, s17
    s_mov_b32 s40, s28
    s_mov_b32 s41, s29
    buffer_load_dword v46, v3, s[40:43], 0 offen sc1
    s_barrier
    s_mov_b32 s80, s10
    s_mov_b32 s81, s11
    s_mov_b32 s44, s4
    s_mov_b32 s45, s5
    buffer_load_dwordx4 v[218:221], v233, s[44:47], 0 offen
    buffer_load_dwordx4 v[222:225], v233, s[44:47], 0 offen offset:16
    buffer_load_dword v226, v233, s[44:47], 0 offen offset:32
    s_mov_b32 s66, 0
    buffer_load_dwordx4 v[136:139], v231, s[80:83], s66 offen nt
    buffer_load_dwordx4 v[140:143], v232, s[80:83], s66 offen nt
    s_mov_b32 s66, 16384
    buffer_load_dwordx4 v[144:147], v231, s[80:83], s66 offen nt
    buffer_load_dwordx4 v[148:151], v232, s[80:83], s66 offen nt
    s_mov_b32 s66, 32768
    buffer_load_dwordx4 v[152:155], v231, s[80:83], s66 offen nt
    buffer_load_dwordx4 v[156:159], v232, s[80:83], s66 offen nt
    s_mov_b32 s66, 49152
    buffer_load_dwordx4 v[160:163], v231, s[80:83], s66 offen nt
    buffer_load_dwordx4 v[164:167], v232, s[80:83], s66 offen nt
    s_mov_b32 s66, 65536
    buffer_load_dwordx4 v[168:171], v231, s[80:83], s66 offen nt
    buffer_load_dwordx4 v[172:175], v232, s[80:83], s66 offen nt
    s_mov_b32 s66, 81920
    buffer_load_dwordx4 v[176:179], v231, s[80:83], s66 offen nt
    buffer_load_dwordx4 v[180:183], v232, s[80:83], s66 offen nt
    s_mov_b32 s66, 98304
    buffer_load_dwordx4 v[184:187], v231, s[80:83], s66 offen nt
    buffer_load_dwordx4 v[188:191], v232, s[80:83], s66 offen nt
    s_mov_b32 s66, 114688
    buffer_load_dwordx4 v[192:195], v231, s[80:83], s66 offen nt
    buffer_load_dwordx4 v[196:199], v232, s[80:83], s66 offen nt
    s_mov_b32 s66, 131072
    buffer_load_dwordx4 v[200:203], v231, s[80:83], s66 offen nt
    buffer_load_dwordx4 v[204:207], v232, s[80:83], s66 offen nt
    v_and_b32 v48, 1, v1
    v_cmp_eq_u32 vcc, 1, v48
    v_mov_b32 v49, 0x01000c0c
    v_mov_b32 v50, 0x03020c0c
    v_mov_b32 v55, 0x0c0c0100
    v_mov_b32 v56, 0x0c0c0302
    v_mov_b32 v51, 0x0c0c0c0c
    v_cndmask_b32 v49, v55, v49, vcc
    v_cndmask_b32 v50, v56, v50, vcc
    v_bfe_u32 v48, v1, 1, 2
    v_cmp_eq_u32 vcc, 0, v48
    s_nop 1
    v_cndmask_b32 v234, v51, v49, vcc
    v_cndmask_b32 v238, v51, v50, vcc
    v_cmp_eq_u32 vcc, 1, v48
    s_nop 1
    v_cndmask_b32 v235, v51, v49, vcc
    v_cndmask_b32 v239, v51, v50, vcc
    v_cmp_eq_u32 vcc, 2, v48
    s_nop 1
    v_cndmask_b32 v236, v51, v49, vcc
    v_cndmask_b32 v240, v51, v50, vcc
    v_cmp_eq_u32 vcc, 3, v48
    s_nop 1
    v_cndmask_b32 v237, v51, v49, vcc
    v_cndmask_b32 v241, v51, v50, vcc
    v_lshrrev_b32 v47, 5, v1
    v_lshlrev_b32 v47, 12, v47
    v_and_b32 v49, 15, v1
    v_lshl_add_u32 v47, v49, 5, v47
    v_and_b32 v49, 16, v1
    v_add_u32 v47, v47, v49
    s_lshl_b32 s66, s31, 13
    s_add_u32 s66, s66, 0x180000
    s_lshl_b32 s67, s69, 9
    s_add_u32 s78, s66, s67
    s_lshl_b32 s67, s51, 12
    s_add_u32 s30, s66, s67
    s_add_u32 s50, s30, 4096
    s_lshl_b32 s66, s60, 13
    s_lshl_b32 s67, s59, 9
    s_add_u32 s66, s66, s67
    s_add_u32 s79, s66, 0x100000
    s_mov_b32 s62, 0
    s_mov_b32 s63, 0
    s_mov_b32 s64, 0
    s_mov_b32 s66, s2
    s_cmp_lt_u32 s2, 144
    s_cbranch_scc0 L_consd1
L_cons1:
    s_lshr_b32 s63, s66, 3
    s_and_b32 s64, s66, 7
    s_mov_b32 s62, 1
    s_cmp_lt_u32 s63, 9
    s_cbranch_scc1 L_consd1
    s_mov_b32 s62, 2
L_consd1:
    s_mul_i32 s66, s60, 256
    s_add_u32 s66, s66, 0x20000
    v_mov_b32 v2, s66
    v_mov_b32 v4, 1
    s_lshl_b32 s49, s60, 21
    s_add_u32 s49, s49, 1572864
    s_mov_b32 s58, 0x3e0293ee
    s_add_u32 s72, s72, 0x64
    s_bitcmp1_b32 s59, 0
    s_mov_b32 s74, 7160
    s_cselect_b32 s74, 7160, s74
    s_lshl_b32 s66, s66, 7
    s_mul_i32 s67, s64, 589824
    s_add_u32 s66, s66, s67
    s_mul_i32 s67, s3, 73728
    s_add_u32 s65, s66, s67
    s_add_u32 s71, s65, 4608
    v_lshrrev_b32 v7, 3, v1
    v_mul_u32_u24 v7, 9216, v7
    v_and_b32 v6, 7, v1
    v_lshl_add_u32 v7, v6, 4, v7
    s_lshl_b32 s26, s77, 2
    s_lshl_b32 s27, s77, 3
    s_mov_b32 s52, 0
    s_mov_b32 s54, 0
    v_lshrrev_b32 v251, 4, v1
    v_lshlrev_b32 v251, 5, v251
    v_add_u32 v251, 0x4d00, v251
    v_and_b32 v43, 12, v1
    v_add_u32 v43, v43, v251
    s_lshl_b32 s66, s31, 11
    s_lshl_b32 s67, s51, 8
    s_add_u32 s66, s66, s67
    s_and_b32 s67, s61, 3
    s_lshl_b32 s67, s67, 6
    s_add_u32 s66, s66, s67
    s_add_u32 s66, s66, 0x30000
    s_and_b32 s68, s60, 15
    s_lshl_b32 s68, s68, 13
    s_lshr_b32 s67, s60, 4
    s_lshl_b32 s67, s67, 9
    s_add_u32 s68, s68, s67
    s_lshl_b32 s67, s59, 6
    s_add_u32 s68, s68, s67
    s_add_u32 s68, s68, 0x50000
    s_sub_u32 s68, s68, 4096
    v_bfe_u32 v50, v1, 2, 2
    v_lshlrev_b32 v49, 12, v44
    v_lshl_add_u32 v49, v50, 10, v49
    v_add_u32 v49, s68, v49
    v_lshlrev_b32 v50, 9, v50
    v_add_u32 v50, s66, v50
    v_cmp_eq_u32 vcc, 0, v44
    s_nop 1
    v_cndmask_b32 v49, v49, v50, vcc
    v_and_b32 v50, 0x30, v0
    v_add_u32 v12, v49, v50
    v_mov_b32 v16, -1
    v_mov_b32 v17, -1
    v_mov_b32 v18, -1
    v_mov_b32 v19, -1
    s_mul_i32 s66, s31, 256
    s_lshl_b32 s67, s51, 5
    s_add_u32 s66, s66, s67
    s_and_b32 s67, s61, 3
    s_lshl_b32 s67, s67, 3
    s_add_u32 s66, s66, s67
    s_add_u32 s66, s66, 0x40000
    s_and_b32 s68, s60, 15
    s_mul_i32 s68, s68, 512
    s_lshr_b32 s67, s60, 4
    s_lshl_b32 s67, s67, 6
    s_add_u32 s68, s68, s67
    s_lshl_b32 s67, s59, 3
    s_add_u32 s68, s68, s67
    s_add_u32 s68, s68, 0x70000
    s_sub_u32 s68, s68, 256
    v_mul_u32_u24 v49, 256, v1
    v_add_u32 v49, s68, v49
    v_mov_b32 v50, s66
    v_cmp_eq_u32 vcc, 0, v1
    s_nop 1
    v_cndmask_b32 v13, v49, v50, vcc
    s_lshl_b32 s69, s63, 3
    s_add_u32 s69, s69, s64
    s_lshl_b32 s69, s69, 9
    s_add_u32 s69, s69, 0x80000
    v_mov_b32 v20, 0
    v_mov_b32 v21, 0
    v_mov_b32 v22, 0
    v_mov_b32 v23, 0
    s_waitcnt vmcnt(40)
    v_perm_b32 v242, v208, v208, v234
    v_perm_b32 v243, v208, v208, v235
    v_perm_b32 v244, v208, v208, v236
    v_perm_b32 v245, v208, v208, v237
    v_perm_b32 v246, v208, v208, v238
    v_perm_b32 v247, v208, v208, v239
    v_perm_b32 v248, v208, v208, v240
    v_perm_b32 v249, v208, v208, v241
    s_waitcnt vmcnt(39)
    v_mfma_f32_16x16x32_bf16 v[20:23], v[242:245], v[64:67], v[20:23]
    s_waitcnt vmcnt(38)
    v_mfma_f32_16x16x32_bf16 v[20:23], v[246:249], v[68:71], v[20:23]
    v_perm_b32 v242, v209, v209, v234
    v_perm_b32 v243, v209, v209, v235
    v_perm_b32 v244, v209, v209, v236
    v_perm_b32 v245, v209, v209, v237
    v_perm_b32 v246, v209, v209, v238
    v_perm_b32 v247, v209, v209, v239
    v_perm_b32 v248, v209, v209, v240
    v_perm_b32 v249, v209, v209, v241
    s_waitcnt vmcnt(37)
    v_mfma_f32_16x16x32_bf16 v[20:23], v[242:245], v[72:75], v[20:23]
    s_waitcnt vmcnt(36)
    v_mfma_f32_16x16x32_bf16 v[20:23], v[246:249], v[76:79], v[20:23]
    v_perm_b32 v242, v210, v210, v234
    v_perm_b32 v243, v210, v210, v235
    v_perm_b32 v244, v210, v210, v236
    v_perm_b32 v245, v210, v210, v237
    v_perm_b32 v246, v210, v210, v238
    v_perm_b32 v247, v210, v210, v239
    v_perm_b32 v248, v210, v210, v240
    v_perm_b32 v249, v210, v210, v241
    s_waitcnt vmcnt(35)
    v_mfma_f32_16x16x32_bf16 v[20:23], v[242:245], v[80:83], v[20:23]
    s_waitcnt vmcnt(34)
    v_mfma_f32_16x16x32_bf16 v[20:23], v[246:249], v[84:87], v[20:23]
    v_perm_b32 v242, v211, v211, v234
    v_perm_b32 v243, v211, v211, v235
    v_perm_b32 v244, v211, v211, v236
    v_perm_b32 v245, v211, v211, v237
    v_perm_b32 v246, v211, v211, v238
    v_perm_b32 v247, v211, v211, v239
    v_perm_b32 v248, v211, v211, v240
    v_perm_b32 v249, v211, v211, v241
    s_waitcnt vmcnt(33)
    v_mfma_f32_16x16x32_bf16 v[20:23], v[242:245], v[88:91], v[20:23]
    s_waitcnt vmcnt(32)
    v_mfma_f32_16x16x32_bf16 v[20:23], v[246:249], v[92:95], v[20:23]
    v_perm_b32 v242, v212, v212, v234
    v_perm_b32 v243, v212, v212, v235
    v_perm_b32 v244, v212, v212, v236
    v_perm_b32 v245, v212, v212, v237
    v_perm_b32 v246, v212, v212, v238
    v_perm_b32 v247, v212, v212, v239
    v_perm_b32 v248, v212, v212, v240
    v_perm_b32 v249, v212, v212, v241
    s_waitcnt vmcnt(31)
    v_mfma_f32_16x16x32_bf16 v[20:23], v[242:245], v[96:99], v[20:23]
    s_waitcnt vmcnt(30)
    v_mfma_f32_16x16x32_bf16 v[20:23], v[246:249], v[100:103], v[20:23]
    v_perm_b32 v242, v213, v213, v234
    v_perm_b32 v243, v213, v213, v235
    v_perm_b32 v244, v213, v213, v236
    v_perm_b32 v245, v213, v213, v237
    v_perm_b32 v246, v213, v213, v238
    v_perm_b32 v247, v213, v213, v239
    v_perm_b32 v248, v213, v213, v240
    v_perm_b32 v249, v213, v213, v241
    s_waitcnt vmcnt(29)
    v_mfma_f32_16x16x32_bf16 v[20:23], v[242:245], v[104:107], v[20:23]
    s_waitcnt vmcnt(28)
    v_mfma_f32_16x16x32_bf16 v[20:23], v[246:249], v[108:111], v[20:23]
    v_perm_b32 v242, v214, v214, v234
    v_perm_b32 v243, v214, v214, v235
    v_perm_b32 v244, v214, v214, v236
    v_perm_b32 v245, v214, v214, v237
    v_perm_b32 v246, v214, v214, v238
    v_perm_b32 v247, v214, v214, v239
    v_perm_b32 v248, v214, v214, v240
    v_perm_b32 v249, v214, v214, v241
    s_waitcnt vmcnt(27)
    v_mfma_f32_16x16x32_bf16 v[20:23], v[242:245], v[112:115], v[20:23]
    s_waitcnt vmcnt(26)
    v_mfma_f32_16x16x32_bf16 v[20:23], v[246:249], v[116:119], v[20:23]
    v_perm_b32 v242, v215, v215, v234
    v_perm_b32 v243, v215, v215, v235
    v_perm_b32 v244, v215, v215, v236
    v_perm_b32 v245, v215, v215, v237
    v_perm_b32 v246, v215, v215, v238
    v_perm_b32 v247, v215, v215, v239
    v_perm_b32 v248, v215, v215, v240
    v_perm_b32 v249, v215, v215, v241
    s_waitcnt vmcnt(25)
    v_mfma_f32_16x16x32_bf16 v[20:23], v[242:245], v[120:123], v[20:23]
    s_waitcnt vmcnt(24)
    v_mfma_f32_16x16x32_bf16 v[20:23], v[246:249], v[124:127], v[20:23]
    v_perm_b32 v242, v216, v216, v234
    v_perm_b32 v243, v216, v216, v235
    v_perm_b32 v244, v216, v216, v236
    v_perm_b32 v245, v216, v216, v237
    v_perm_b32 v246, v216, v216, v238
    v_perm_b32 v247, v216, v216, v239
    v_perm_b32 v248, v216, v216, v240
    v_perm_b32 v249, v216, v216, v241
    s_waitcnt vmcnt(23)
    v_mfma_f32_16x16x32_bf16 v[20:23], v[242:245], v[128:131], v[20:23]
    s_waitcnt vmcnt(22)
    v_mfma_f32_16x16x32_bf16 v[20:23], v[246:249], v[132:135], v[20:23]
    s_nop 7
    s_waitcnt vmcnt(21)
    v_readfirstlane_b32 s66, v46
    s_nop 3
    s_mul_i32 s56, s66, 0x9E3779B1
    s_add_u32 s56, s56, 0x7F4A7C15
    s_bfe_u32 s80, s56, 0x80000
    s_bfe_u32 s81, s56, 0x80008
    s_bfe_u32 s82, s56, 0x80010
    s_bfe_u32 s83, s56, 0x80018
    v_mov_b32 v56, 0xffffff00
    v_add_u32 v52, 0x80, v20
    v_add_u32 v53, 0x80, v21
    v_add_u32 v54, 0x80, v22
    v_add_u32 v55, 0x80, v23
    v_and_or_b32 v52, v52, v56, s80
    v_and_or_b32 v53, v53, v56, s81
    v_and_or_b32 v54, v54, v56, s82
    v_and_or_b32 v55, v55, v56, s83
    buffer_store_dwordx4 v[52:55], v47, s[40:43], s78 offen sc1
    v_mov_b32 v20, 0
    v_mov_b32 v21, 0
    v_mov_b32 v22, 0
    v_mov_b32 v23, 0
    s_waitcnt vmcnt(19)
    v_perm_b32 v242, v218, v218, v234
    v_perm_b32 v243, v218, v218, v235
    v_perm_b32 v244, v218, v218, v236
    v_perm_b32 v245, v218, v218, v237
    v_perm_b32 v246, v218, v218, v238
    v_perm_b32 v247, v218, v218, v239
    v_perm_b32 v248, v218, v218, v240
    v_perm_b32 v249, v218, v218, v241
    s_waitcnt vmcnt(18)
    v_mfma_f32_16x16x32_bf16 v[20:23], v[242:245], v[136:139], v[20:23]
    s_waitcnt vmcnt(17)
    v_mfma_f32_16x16x32_bf16 v[20:23], v[246:249], v[140:143], v[20:23]
    v_perm_b32 v242, v219, v219, v234
    v_perm_b32 v243, v219, v219, v235
    v_perm_b32 v244, v219, v219, v236
    v_perm_b32 v245, v219, v219, v237
    v_perm_b32 v246, v219, v219, v238
    v_perm_b32 v247, v219, v219, v239
    v_perm_b32 v248, v219, v219, v240
    v_perm_b32 v249, v219, v219, v241
    s_waitcnt vmcnt(16)
    v_mfma_f32_16x16x32_bf16 v[20:23], v[242:245], v[144:147], v[20:23]
    s_waitcnt vmcnt(15)
    v_mfma_f32_16x16x32_bf16 v[20:23], v[246:249], v[148:151], v[20:23]
    v_perm_b32 v242, v220, v220, v234
    v_perm_b32 v243, v220, v220, v235
    v_perm_b32 v244, v220, v220, v236
    v_perm_b32 v245, v220, v220, v237
    v_perm_b32 v246, v220, v220, v238
    v_perm_b32 v247, v220, v220, v239
    v_perm_b32 v248, v220, v220, v240
    v_perm_b32 v249, v220, v220, v241
    s_waitcnt vmcnt(14)
    v_mfma_f32_16x16x32_bf16 v[20:23], v[242:245], v[152:155], v[20:23]
    s_waitcnt vmcnt(13)
    v_mfma_f32_16x16x32_bf16 v[20:23], v[246:249], v[156:159], v[20:23]
    v_perm_b32 v242, v221, v221, v234
    v_perm_b32 v243, v221, v221, v235
    v_perm_b32 v244, v221, v221, v236
    v_perm_b32 v245, v221, v221, v237
    v_perm_b32 v246, v221, v221, v238
    v_perm_b32 v247, v221, v221, v239
    v_perm_b32 v248, v221, v221, v240
    v_perm_b32 v249, v221, v221, v241
    s_waitcnt vmcnt(12)
    v_mfma_f32_16x16x32_bf16 v[20:23], v[242:245], v[160:163], v[20:23]
    s_waitcnt vmcnt(11)
    v_mfma_f32_16x16x32_bf16 v[20:23], v[246:249], v[164:167], v[20:23]
    v_perm_b32 v242, v222, v222, v234
    v_perm_b32 v243, v222, v222, v235
    v_perm_b32 v244, v222, v222, v236
    v_perm_b32 v245, v222, v222, v237
    v_perm_b32 v246, v222, v222, v238
    v_perm_b32 v247, v222, v222, v239
    v_perm_b32 v248, v222, v222, v240
    v_perm_b32 v249, v222, v222, v241
    s_waitcnt vmcnt(10)
    v_mfma_f32_16x16x32_bf16 v[20:23], v[242:245], v[168:171], v[20:23]
    s_waitcnt vmcnt(9)
    v_mfma_f32_16x16x32_bf16 v[20:23], v[246:249], v[172:175], v[20:23]
    v_perm_b32 v242, v223, v223, v234
    v_perm_b32 v243, v223, v223, v235
    v_perm_b32 v244, v223, v223, v236
    v_perm_b32 v245, v223, v223, v237
    v_perm_b32 v246, v223, v223, v238
    v_perm_b32 v247, v223, v223, v239
    v_perm_b32 v248, v223, v223, v240
    v_perm_b32 v249, v223, v223, v241
    s_waitcnt vmcnt(8)
    v_mfma_f32_16x16x32_bf16 v[20:23], v[242:245], v[176:179], v[20:23]
    s_waitcnt vmcnt(7)
    v_mfma_f32_16x16x32_bf16 v[20:23], v[246:249], v[180:183], v[20:23]
    v_perm_b32 v242, v224, v224, v234
    v_perm_b32 v243, v224, v224, v235
    v_perm_b32 v244, v224, v224, v236
    v_perm_b32 v245, v224, v224, v237
    v_perm_b32 v246, v224, v224, v238
    v_perm_b32 v247, v224, v224, v239
    v_perm_b32 v248, v224, v224, v240
    v_perm_b32 v249, v224, v224, v241
    s_waitcnt vmcnt(6)
    v_mfma_f32_16x16x32_bf16 v[20:23], v[242:245], v[184:187], v[20:23]
    s_waitcnt vmcnt(5)
    v_mfma_f32_16x16x32_bf16 v[20:23], v[246:249], v[188:191], v[20:23]
    v_perm_b32 v242, v225, v225, v234
    v_perm_b32 v243, v225, v225, v235
    v_perm_b32 v244, v225, v225, v236
    v_perm_b32 v245, v225, v225, v237
    v_perm_b32 v246, v225, v225, v238
    v_perm_b32 v247, v225, v225, v239
    v_perm_b32 v248, v225, v225, v240
    v_perm_b32 v249, v225, v225, v241
    s_waitcnt vmcnt(4)
    v_mfma_f32_16x16x32_bf16 v[20:23], v[242:245], v[192:195], v[20:23]
    s_waitcnt vmcnt(3)
    v_mfma_f32_16x16x32_bf16 v[20:23], v[246:249], v[196:199], v[20:23]
    v_perm_b32 v242, v226, v226, v234
    v_perm_b32 v243, v226, v226, v235
    v_perm_b32 v244, v226, v226, v236
    v_perm_b32 v245, v226, v226, v237
    v_perm_b32 v246, v226, v226, v238
    v_perm_b32 v247, v226, v226, v239
    v_perm_b32 v248, v226, v226, v240
    v_perm_b32 v249, v226, v226, v241
    s_waitcnt vmcnt(2)
    v_mfma_f32_16x16x32_bf16 v[20:23], v[242:245], v[200:203], v[20:23]
    s_waitcnt vmcnt(1)
    v_mfma_f32_16x16x32_bf16 v[20:23], v[246:249], v[204:207], v[20:23]
    s_nop 7
    v_add_u32 v52, 0x80, v20
    v_add_u32 v53, 0x80, v21
    v_add_u32 v54, 0x80, v22
    v_add_u32 v55, 0x80, v23
    v_and_or_b32 v52, v52, v56, s80
    v_and_or_b32 v53, v53, v56, s81
    v_and_or_b32 v54, v54, v56, s82
    v_and_or_b32 v55, v55, v56, s83
    buffer_store_dwordx4 v[52:55], v47, s[40:43], s79 offen sc1
    s_mov_b64 exec, 1
    s_cmp_eq_u32 s59, 0
    s_cbranch_scc0 L_notc
    buffer_store_dword v3, v2, s[40:43], 0 offen sc1
L_notc:
    s_mov_b64 exec, 7
    buffer_store_dwordx2 v[16:17], v13, s[40:43], 0 offen sc1
    s_mov_b32 exec_lo, -1
    s_mov_b32 exec_hi, 0xffff
    buffer_store_dwordx4 v[16:19], v12, s[40:43], 0 offen sc1
    s_mov_b32 exec_hi, 0
    s_cmp_eq_u32 s62, 0
    s_cbranch_scc1 L_noyc
    s_cmp_eq_u32 s64, 0
    s_cbranch_scc0 L_noyc
    s_mov_b64 exec, -1
    s_mov_b32 s44, s24
    s_mov_b32 s45, s25
    s_mov_b32 s46, 4608
    s_mov_b32 s47, 0x20000
    s_lshl_b32 s69, s63, 7
    v_lshrrev_b32 v49, 5, v1
    v_mul_u32_u24 v49, 2304, v49
    v_and_b32 v50, 31, v1
    v_lshl_add_u32 v49, v50, 2, v49
    buffer_store_dword v3, v49, s[44:47], s69 offen sc1
L_noyc:
    s_mov_b64 exec, -1
    buffer_load_dwordx4 v[96:99], v0, s[40:43], s30 offen offset:0 sc1
    buffer_load_dwordx4 v[100:103], v0, s[40:43], s30 offen offset:1024 sc1
    buffer_load_dwordx4 v[104:107], v0, s[40:43], s30 offen offset:2048 sc1
    buffer_load_dwordx4 v[108:111], v0, s[40:43], s30 offen offset:3072 sc1
    v_add_u32 v42, 0x10000, v0
    s_mov_b32 s68, 28
    s_bfe_u32 s66, s68, 0x20000
    s_lshl_b32 s66, s66, 12
    s_add_u32 s50, s48, s66
    s_bfe_u32 s66, s68, 0x10002
    s_lshl_b32 s66, s66, 18
    s_add_u32 s50, s50, s66
    s_bfe_u32 s66, s68, 0x10003
    s_lshl_b32 s66, s66, 17
    s_add_u32 s50, s50, s66
    s_bfe_u32 s66, s68, 0x10004
    s_lshl_b32 s66, s66, 19
    s_add_u32 s50, s50, s66
    s_bfe_u32 s66, s68, 0x10005
    s_lshl_b32 s66, s66, 14
    s_add_u32 s50, s50, s66
    s_mov_b32 s53, 29
    buffer_load_dwordx4 v[64:67], v0, s[32:35], s50 offen offset:0 nt
    buffer_load_dwordx4 v[68:71], v0, s[32:35], s50 offen offset:1024 nt
    buffer_load_dwordx4 v[72:75], v0, s[32:35], s50 offen offset:2048 nt
    buffer_load_dwordx4 v[76:79], v0, s[32:35], s50 offen offset:3072 nt
    buffer_load_dwordx4 v[80:83], v42, s[36:39], s50 offen offset:0 nt
    buffer_load_dwordx4 v[84:87], v42, s[36:39], s50 offen offset:1024 nt
    buffer_load_dwordx4 v[88:91], v42, s[36:39], s50 offen offset:2048 nt
    buffer_load_dwordx4 v[92:95], v42, s[36:39], s50 offen offset:3072 nt
    s_mov_b32 s70, 0
    s_waitcnt vmcnt(8)
L_qpoll:
    s_mov_b32 s68, 0
    v_xor_b32 v48, s80, v96
    v_xor_b32 v49, s81, v97
    v_or_b32 v48, v48, v49
    v_xor_b32 v49, s82, v98
    v_or_b32 v48, v48, v49
    v_xor_b32 v49, s83, v99
    v_or_b32 v48, v48, v49
    v_and_b32 v48, 0xff, v48
    v_cmp_ne_u32 vcc, 0, v48
    s_cbranch_vccz L_qs0
    buffer_load_dwordx4 v[96:99], v0, s[40:43], s30 offen offset:0 sc1
    s_mov_b32 s68, 1
L_qs0:
    v_xor_b32 v48, s80, v100
    v_xor_b32 v49, s81, v101
    v_or_b32 v48, v48, v49
    v_xor_b32 v49, s82, v102
    v_or_b32 v48, v48, v49
    v_xor_b32 v49, s83, v103
    v_or_b32 v48, v48, v49
    v_and_b32 v48, 0xff, v48
    v_cmp_ne_u32 vcc, 0, v48
    s_cbranch_vccz L_qs1
    buffer_load_dwordx4 v[100:103], v0, s[40:43], s30 offen offset:1024 sc1
    s_mov_b32 s68, 1
L_qs1:
    v_xor_b32 v48, s80, v104
    v_xor_b32 v49, s81, v105
    v_or_b32 v48, v48, v49
    v_xor_b32 v49, s82, v106
    v_or_b32 v48, v48, v49
    v_xor_b32 v49, s83, v107
    v_or_b32 v48, v48, v49
    v_and_b32 v48, 0xff, v48
    v_cmp_ne_u32 vcc, 0, v48
    s_cbranch_vccz L_qs2
    buffer_load_dwordx4 v[104:107], v0, s[40:43], s30 offen offset:2048 sc1
    s_mov_b32 s68, 1
L_qs2:
    v_xor_b32 v48, s80, v108
    v_xor_b32 v49, s81, v109
    v_or_b32 v48, v48, v49
    v_xor_b32 v49, s82, v110
    v_or_b32 v48, v48, v49
    v_xor_b32 v49, s83, v111
    v_or_b32 v48, v48, v49
    v_and_b32 v48, 0xff, v48
    v_cmp_ne_u32 vcc, 0, v48
    s_cbranch_vccz L_qs3
    buffer_load_dwordx4 v[108:111], v0, s[40:43], s30 offen offset:3072 sc1
    s_mov_b32 s68, 1
L_qs3:
    s_cmp_eq_u32 s68, 0
    s_cbranch_scc1 L_qok
    s_waitcnt vmcnt(0)
    s_add_u32 s70, s70, 1
    s_cmp_lt_u32 s70, 200000
    s_cbranch_scc1 L_qpoll
L_qok:
    v_xor_b32 v96, s80, v96
    v_xor_b32 v97, s81, v97
    v_xor_b32 v98, s82, v98
    v_xor_b32 v99, s83, v99
    v_xor_b32 v100, s80, v100
    v_xor_b32 v101, s81, v101
    v_xor_b32 v102, s82, v102
    v_xor_b32 v103, s83, v103
    v_xor_b32 v104, s80, v104
    v_xor_b32 v105, s81, v105
    v_xor_b32 v106, s82, v106
    v_xor_b32 v107, s83, v107
    v_xor_b32 v108, s80, v108
    v_xor_b32 v109, s81, v109
    v_xor_b32 v110, s82, v110
    v_xor_b32 v111, s83, v111
    v_add_f32 v96, v96, v104
    v_add_f32 v97, v97, v105
    v_add_f32 v98, v98, v106
    v_add_f32 v99, v99, v107
    v_add_f32 v100, v100, v108
    v_add_f32 v101, v101, v109
    v_add_f32 v102, v102, v110
    v_add_f32 v103, v103, v111
    v_add_f32 v96, v96, v100
    v_add_f32 v97, v97, v101
    v_add_f32 v98, v98, v102
    v_add_f32 v99, v99, v103
    v_mov_b32 v100, v96
    v_mov_b32 v101, v97
    v_mov_b32 v102, v98
    v_mov_b32 v103, v99
    s_nop 0
    v_permlane32_swap_b32 v96, v100
    v_permlane32_swap_b32 v97, v101
    v_permlane32_swap_b32 v98, v102
    v_permlane32_swap_b32 v99, v103
    v_add_f32 v96, v96, v100
    v_add_f32 v97, v97, v101
    v_add_f32 v98, v98, v102
    v_add_f32 v99, v99, v103
    v_cvt_pk_bf16_f32 v52, v96, v97
    v_cvt_pk_bf16_f32 v53, v98, v99
    v_and_b32 v48, 31, v1
    v_lshlrev_b32 v48, 3, v48
    v_mov_b32 v50, 1
    v_mov_b32 v51, s56
    s_mov_b32 exec_hi, 0
    ds_write_b64 v48, v[52:53] offset:19456
    s_mov_b64 exec, 1
    ds_write_b64 v3, v[50:51] offset:16
    s_lshl_b32 s66, s2, 2
    s_add_u32 s66, s66, 0x8000
    buffer_store_dword v51, v3, s[40:43], s66 offen sc1
    s_mov_b64 exec, -1
    s_setprio 0
    v_and_b32 v48, 0xf0, v0
    ds_read_b128 v[8:11], v48 offset:19456
    v_mov_b32 v20, 0
    v_mov_b32 v21, 0
    v_mov_b32 v22, 0
    v_mov_b32 v23, 0
    v_mov_b32 v24, 0
    v_mov_b32 v25, 0
    v_mov_b32 v26, 0
    v_mov_b32 v27, 0
    v_mov_b32 v28, 0
    v_mov_b32 v29, 0
    v_mov_b32 v30, 0
    v_mov_b32 v31, 0
    v_mov_b32 v32, 0
    v_mov_b32 v33, 0
    v_mov_b32 v34, 0
    v_mov_b32 v35, 0
    v_mov_b32 v36, 0xff61b1e6
    v_mul_f32 v38, s58, v36
    v_mov_b32 v40, 0
    v_mov_b32 v37, 0xff61b1e6
    v_mul_f32 v39, s58, v37
    v_mov_b32 v41, 0
    s_waitcnt lgkmcnt(0)
    s_mov_b32 s79, 28
    s_branch L_K
L_peel:
    s_sub_u32 s79, s3, 1
    s_waitcnt vmcnt(31)
    v_mov_b32 v44, 0
    v_dot2c_f32_bf16 v44, v96, v8
    v_dot2c_f32_bf16 v44, v97, v9
    v_dot2c_f32_bf16 v44, v98, v10
    v_dot2c_f32_bf16 v44, v99, v11
    s_waitcnt vmcnt(30)
    v_mov_b32 v45, 0
    v_dot2c_f32_bf16 v45, v100, v8
    v_dot2c_f32_bf16 v45, v101, v9
    v_dot2c_f32_bf16 v45, v102, v10
    v_dot2c_f32_bf16 v45, v103, v11
    s_waitcnt vmcnt(29)
    v_mov_b32 v46, 0
    v_dot2c_f32_bf16 v46, v104, v8
    v_dot2c_f32_bf16 v46, v105, v9
    v_dot2c_f32_bf16 v46, v106, v10
    v_dot2c_f32_bf16 v46, v107, v11
    s_waitcnt vmcnt(28)
    v_mov_b32 v47, 0
    v_dot2c_f32_bf16 v47, v108, v8
    v_dot2c_f32_bf16 v47, v109, v9
    v_dot2c_f32_bf16 v47, v110, v10
    v_dot2c_f32_bf16 v47, v111, v11
    s_waitcnt vmcnt(27)
    v_mov_b32 v48, 0
    v_dot2c_f32_bf16 v48, v112, v8
    v_dot2c_f32_bf16 v48, v113, v9
    v_dot2c_f32_bf16 v48, v114, v10
    v_dot2c_f32_bf16 v48, v115, v11
    s_waitcnt vmcnt(26)
    v_mov_b32 v49, 0
    v_dot2c_f32_bf16 v49, v116, v8
    v_dot2c_f32_bf16 v49, v117, v9
    v_dot2c_f32_bf16 v49, v118, v10
    v_dot2c_f32_bf16 v49, v119, v11
    s_waitcnt vmcnt(25)
    v_mov_b32 v50, 0
    v_dot2c_f32_bf16 v50, v120, v8
    v_dot2c_f32_bf16 v50, v121, v9
    v_dot2c_f32_bf16 v50, v122, v10
    v_dot2c_f32_bf16 v50, v123, v11
    s_waitcnt vmcnt(24)
    v_mov_b32 v51, 0
    v_dot2c_f32_bf16 v51, v124, v8
    v_dot2c_f32_bf16 v51, v125, v9
    v_dot2c_f32_bf16 v51, v126, v10
    v_dot2c_f32_bf16 v51, v127, v11
    s_lshl_b32 s66, s79, 7
    v_add_u32 v54, s66, v43
    s_nop 1
    v_add_f32_dpp v44, v44, v44 quad_perm:[1,0,3,2] row_mask:0xf bank_mask:0xf
    v_add_f32_dpp v45, v45, v45 quad_perm:[1,0,3,2] row_mask:0xf bank_mask:0xf
    v_add_f32_dpp v46, v46, v46 quad_perm:[1,0,3,2] row_mask:0xf bank_mask:0xf
    v_add_f32_dpp v47, v47, v47 quad_perm:[1,0,3,2] row_mask:0xf bank_mask:0xf
    v_add_f32_dpp v48, v48, v48 quad_perm:[1,0,3,2] row_mask:0xf bank_mask:0xf
    v_add_f32_dpp v49, v49, v49 quad_perm:[1,0,3,2] row_mask:0xf bank_mask:0xf
    v_add_f32_dpp v50, v50, v50 quad_perm:[1,0,3,2] row_mask:0xf bank_mask:0xf
    v_add_f32_dpp v51, v51, v51 quad_perm:[1,0,3,2] row_mask:0xf bank_mask:0xf
    v_add_f32_dpp v44, v44, v44 quad_perm:[2,3,0,1] row_mask:0xf bank_mask:0xf
    v_add_f32_dpp v45, v45, v45 quad_perm:[2,3,0,1] row_mask:0xf bank_mask:0xf
    v_add_f32_dpp v46, v46, v46 quad_perm:[2,3,0,1] row_mask:0xf bank_mask:0xf
    v_add_f32_dpp v47, v47, v47 quad_perm:[2,3,0,1] row_mask:0xf bank_mask:0xf
    v_add_f32_dpp v48, v48, v48 quad_perm:[2,3,0,1] row_mask:0xf bank_mask:0xf
    v_add_f32_dpp v49, v49, v49 quad_perm:[2,3,0,1] row_mask:0xf bank_mask:0xf
    v_add_f32_dpp v50, v50, v50 quad_perm:[2,3,0,1] row_mask:0xf bank_mask:0xf
    v_add_f32_dpp v51, v51, v51 quad_perm:[2,3,0,1] row_mask:0xf bank_mask:0xf
    v_add_f32_dpp v44, v44, v44 row_half_mirror row_mask:0xf bank_mask:0xf
    v_add_f32_dpp v45, v45, v45 row_half_mirror row_mask:0xf bank_mask:0xf
    v_add_f32_dpp v46, v46, v46 row_half_mirror row_mask:0xf bank_mask:0xf
    v_add_f32_dpp v47, v47, v47 row_half_mirror row_mask:0xf bank_mask:0xf
    v_add_f32_dpp v48, v48, v48 row_half_mirror row_mask:0xf bank_mask:0xf
    v_add_f32_dpp v49, v49, v49 row_half_mirror row_mask:0xf bank_mask:0xf
    v_add_f32_dpp v50, v50, v50 row_half_mirror row_mask:0xf bank_mask:0xf
    v_add_f32_dpp v51, v51, v51 row_half_mirror row_mask:0xf bank_mask:0xf
    v_add_f32_dpp v52, v44, v44 row_mirror row_mask:0xf bank_mask:0x1
    v_add_f32_dpp v52, v45, v45 row_mirror row_mask:0xf bank_mask:0x2
    v_add_f32_dpp v52, v46, v46 row_mirror row_mask:0xf bank_mask:0x4
    v_add_f32_dpp v52, v47, v47 row_mirror row_mask:0xf bank_mask:0x8
    v_add_f32_dpp v53, v48, v48 row_mirror row_mask:0xf bank_mask:0x1
    v_add_f32_dpp v53, v49, v49 row_mirror row_mask:0xf bank_mask:0x2
    v_add_f32_dpp v53, v50, v50 row_mirror row_mask:0xf bank_mask:0x4
    v_add_f32_dpp v53, v51, v51 row_mirror row_mask:0xf bank_mask:0x8
    v_max3_f32 v36, v36, v52, v53
    ds_write2_b32 v54, v52, v53 offset0:0 offset1:4
    s_add_u32 s79, s79, 7
    s_nop 2
    s_waitcnt vmcnt(23)
    v_mov_b32 v44, 0
    v_dot2c_f32_bf16 v44, v128, v8
    v_dot2c_f32_bf16 v44, v129, v9
    v_dot2c_f32_bf16 v44, v130, v10
    v_dot2c_f32_bf16 v44, v131, v11
    s_waitcnt vmcnt(22)
    v_mov_b32 v45, 0
    v_dot2c_f32_bf16 v45, v132, v8
    v_dot2c_f32_bf16 v45, v133, v9
    v_dot2c_f32_bf16 v45, v134, v10
    v_dot2c_f32_bf16 v45, v135, v11
    s_waitcnt vmcnt(21)
    v_mov_b32 v46, 0
    v_dot2c_f32_bf16 v46, v136, v8
    v_dot2c_f32_bf16 v46, v137, v9
    v_dot2c_f32_bf16 v46, v138, v10
    v_dot2c_f32_bf16 v46, v139, v11
    s_waitcnt vmcnt(20)
    v_mov_b32 v47, 0
    v_dot2c_f32_bf16 v47, v140, v8
    v_dot2c_f32_bf16 v47, v141, v9
    v_dot2c_f32_bf16 v47, v142, v10
    v_dot2c_f32_bf16 v47, v143, v11
    s_waitcnt vmcnt(19)
    v_mov_b32 v48, 0
    v_dot2c_f32_bf16 v48, v144, v8
    v_dot2c_f32_bf16 v48, v145, v9
    v_dot2c_f32_bf16 v48, v146, v10
    v_dot2c_f32_bf16 v48, v147, v11
    s_waitcnt vmcnt(18)
    v_mov_b32 v49, 0
    v_dot2c_f32_bf16 v49, v148, v8
    v_dot2c_f32_bf16 v49, v149, v9
    v_dot2c_f32_bf16 v49, v150, v10
    v_dot2c_f32_bf16 v49, v151, v11
    s_waitcnt vmcnt(17)
    v_mov_b32 v50, 0
    v_dot2c_f32_bf16 v50, v152, v8
    v_dot2c_f32_bf16 v50, v153, v9
    v_dot2c_f32_bf16 v50, v154, v10
    v_dot2c_f32_bf16 v50, v155, v11
    s_waitcnt vmcnt(16)
    v_mov_b32 v51, 0
    v_dot2c_f32_bf16 v51, v156, v8
    v_dot2c_f32_bf16 v51, v157, v9
    v_dot2c_f32_bf16 v51, v158, v10
    v_dot2c_f32_bf16 v51, v159, v11
    s_lshl_b32 s66, s79, 7
    v_add_u32 v54, s66, v43
    s_nop 1
    v_add_f32_dpp v44, v44, v44 quad_perm:[1,0,3,2] row_mask:0xf bank_mask:0xf
    v_add_f32_dpp v45, v45, v45 quad_perm:[1,0,3,2] row_mask:0xf bank_mask:0xf
    v_add_f32_dpp v46, v46, v46 quad_perm:[1,0,3,2] row_mask:0xf bank_mask:0xf
    v_add_f32_dpp v47, v47, v47 quad_perm:[1,0,3,2] row_mask:0xf bank_mask:0xf
    v_add_f32_dpp v48, v48, v48 quad_perm:[1,0,3,2] row_mask:0xf bank_mask:0xf
    v_add_f32_dpp v49, v49, v49 quad_perm:[1,0,3,2] row_mask:0xf bank_mask:0xf
    v_add_f32_dpp v50, v50, v50 quad_perm:[1,0,3,2] row_mask:0xf bank_mask:0xf
    v_add_f32_dpp v51, v51, v51 quad_perm:[1,0,3,2] row_mask:0xf bank_mask:0xf
    v_add_f32_dpp v44, v44, v44 quad_perm:[2,3,0,1] row_mask:0xf bank_mask:0xf
    v_add_f32_dpp v45, v45, v45 quad_perm:[2,3,0,1] row_mask:0xf bank_mask:0xf
    v_add_f32_dpp v46, v46, v46 quad_perm:[2,3,0,1] row_mask:0xf bank_mask:0xf
    v_add_f32_dpp v47, v47, v47 quad_perm:[2,3,0,1] row_mask:0xf bank_mask:0xf
    v_add_f32_dpp v48, v48, v48 quad_perm:[2,3,0,1] row_mask:0xf bank_mask:0xf
    v_add_f32_dpp v49, v49, v49 quad_perm:[2,3,0,1] row_mask:0xf bank_mask:0xf
    v_add_f32_dpp v50, v50, v50 quad_perm:[2,3,0,1] row_mask:0xf bank_mask:0xf
    v_add_f32_dpp v51, v51, v51 quad_perm:[2,3,0,1] row_mask:0xf bank_mask:0xf
    v_add_f32_dpp v44, v44, v44 row_half_mirror row_mask:0xf bank_mask:0xf
    v_add_f32_dpp v45, v45, v45 row_half_mirror row_mask:0xf bank_mask:0xf
    v_add_f32_dpp v46, v46, v46 row_half_mirror row_mask:0xf bank_mask:0xf
    v_add_f32_dpp v47, v47, v47 row_half_mirror row_mask:0xf bank_mask:0xf
    v_add_f32_dpp v48, v48, v48 row_half_mirror row_mask:0xf bank_mask:0xf
    v_add_f32_dpp v49, v49, v49 row_half_mirror row_mask:0xf bank_mask:0xf
    v_add_f32_dpp v50, v50, v50 row_half_mirror row_mask:0xf bank_mask:0xf
    v_add_f32_dpp v51, v51, v51 row_half_mirror row_mask:0xf bank_mask:0xf
    v_add_f32_dpp v52, v44, v44 row_mirror row_mask:0xf bank_mask:0x1
    v_add_f32_dpp v52, v45, v45 row_mirror row_mask:0xf bank_mask:0x2
    v_add_f32_dpp v52, v46, v46 row_mirror row_mask:0xf bank_mask:0x4
    v_add_f32_dpp v52, v47, v47 row_mirror row_mask:0xf bank_mask:0x8
    v_add_f32_dpp v53, v48, v48 row_mirror row_mask:0xf bank_mask:0x1
    v_add_f32_dpp v53, v49, v49 row_mirror row_mask:0xf bank_mask:0x2
    v_add_f32_dpp v53, v50, v50 row_mirror row_mask:0xf bank_mask:0x4
    v_add_f32_dpp v53, v51, v51 row_mirror row_mask:0xf bank_mask:0x8
    v_max3_f32 v36, v36, v52, v53
    ds_write2_b32 v54, v52, v53 offset0:0 offset1:4
    s_add_u32 s79, s79, 7
    s_nop 2
    s_waitcnt vmcnt(15)
    v_mov_b32 v44, 0
    v_dot2c_f32_bf16 v44, v160, v8
    v_dot2c_f32_bf16 v44, v161, v9
    v_dot2c_f32_bf16 v44, v162, v10
    v_dot2c_f32_bf16 v44, v163, v11
    s_waitcnt vmcnt(14)
    v_mov_b32 v45, 0
    v_dot2c_f32_bf16 v45, v164, v8
    v_dot2c_f32_bf16 v45, v165, v9
    v_dot2c_f32_bf16 v45, v166, v10
    v_dot2c_f32_bf16 v45, v167, v11
    s_waitcnt vmcnt(13)
    v_mov_b32 v46, 0
    v_dot2c_f32_bf16 v46, v168, v8
    v_dot2c_f32_bf16 v46, v169, v9
    v_dot2c_f32_bf16 v46, v170, v10
    v_dot2c_f32_bf16 v46, v171, v11
    s_waitcnt vmcnt(12)
    v_mov_b32 v47, 0
    v_dot2c_f32_bf16 v47, v172, v8
    v_dot2c_f32_bf16 v47, v173, v9
    v_dot2c_f32_bf16 v47, v174, v10
    v_dot2c_f32_bf16 v47, v175, v11
    s_waitcnt vmcnt(11)
    v_mov_b32 v48, 0
    v_dot2c_f32_bf16 v48, v176, v8
    v_dot2c_f32_bf16 v48, v177, v9
    v_dot2c_f32_bf16 v48, v178, v10
    v_dot2c_f32_bf16 v48, v179, v11
    s_waitcnt vmcnt(10)
    v_mov_b32 v49, 0
    v_dot2c_f32_bf16 v49, v180, v8
    v_dot2c_f32_bf16 v49, v181, v9
    v_dot2c_f32_bf16 v49, v182, v10
    v_dot2c_f32_bf16 v49, v183, v11
    s_waitcnt vmcnt(9)
    v_mov_b32 v50, 0
    v_dot2c_f32_bf16 v50, v184, v8
    v_dot2c_f32_bf16 v50, v185, v9
    v_dot2c_f32_bf16 v50, v186, v10
    v_dot2c_f32_bf16 v50, v187, v11
    s_waitcnt vmcnt(8)
    v_mov_b32 v51, 0
    v_dot2c_f32_bf16 v51, v188, v8
    v_dot2c_f32_bf16 v51, v189, v9
    v_dot2c_f32_bf16 v51, v190, v10
    v_dot2c_f32_bf16 v51, v191, v11
    s_lshl_b32 s66, s79, 7
    v_add_u32 v54, s66, v43
    s_nop 1
    v_add_f32_dpp v44, v44, v44 quad_perm:[1,0,3,2] row_mask:0xf bank_mask:0xf
    v_add_f32_dpp v45, v45, v45 quad_perm:[1,0,3,2] row_mask:0xf bank_mask:0xf
    v_add_f32_dpp v46, v46, v46 quad_perm:[1,0,3,2] row_mask:0xf bank_mask:0xf
    v_add_f32_dpp v47, v47, v47 quad_perm:[1,0,3,2] row_mask:0xf bank_mask:0xf
    v_add_f32_dpp v48, v48, v48 quad_perm:[1,0,3,2] row_mask:0xf bank_mask:0xf
    v_add_f32_dpp v49, v49, v49 quad_perm:[1,0,3,2] row_mask:0xf bank_mask:0xf
    v_add_f32_dpp v50, v50, v50 quad_perm:[1,0,3,2] row_mask:0xf bank_mask:0xf
    v_add_f32_dpp v51, v51, v51 quad_perm:[1,0,3,2] row_mask:0xf bank_mask:0xf
    v_add_f32_dpp v44, v44, v44 quad_perm:[2,3,0,1] row_mask:0xf bank_mask:0xf
    v_add_f32_dpp v45, v45, v45 quad_perm:[2,3,0,1] row_mask:0xf bank_mask:0xf
    v_add_f32_dpp v46, v46, v46 quad_perm:[2,3,0,1] row_mask:0xf bank_mask:0xf
    v_add_f32_dpp v47, v47, v47 quad_perm:[2,3,0,1] row_mask:0xf bank_mask:0xf
    v_add_f32_dpp v48, v48, v48 quad_perm:[2,3,0,1] row_mask:0xf bank_mask:0xf
    v_add_f32_dpp v49, v49, v49 quad_perm:[2,3,0,1] row_mask:0xf bank_mask:0xf
    v_add_f32_dpp v50, v50, v50 quad_perm:[2,3,0,1] row_mask:0xf bank_mask:0xf
    v_add_f32_dpp v51, v51, v51 quad_perm:[2,3,0,1] row_mask:0xf bank_mask:0xf
    v_add_f32_dpp v44, v44, v44 row_half_mirror row_mask:0xf bank_mask:0xf
    v_add_f32_dpp v45, v45, v45 row_half_mirror row_mask:0xf bank_mask:0xf
    v_add_f32_dpp v46, v46, v46 row_half_mirror row_mask:0xf bank_mask:0xf
    v_add_f32_dpp v47, v47, v47 row_half_mirror row_mask:0xf bank_mask:0xf
    v_add_f32_dpp v48, v48, v48 row_half_mirror row_mask:0xf bank_mask:0xf
    v_add_f32_dpp v49, v49, v49 row_half_mirror row_mask:0xf bank_mask:0xf
    v_add_f32_dpp v50, v50, v50 row_half_mirror row_mask:0xf bank_mask:0xf
    v_add_f32_dpp v51, v51, v51 row_half_mirror row_mask:0xf bank_mask:0xf
    v_add_f32_dpp v52, v44, v44 row_mirror row_mask:0xf bank_mask:0x1
    v_add_f32_dpp v52, v45, v45 row_mirror row_mask:0xf bank_mask:0x2
    v_add_f32_dpp v52, v46, v46 row_mirror row_mask:0xf bank_mask:0x4
    v_add_f32_dpp v52, v47, v47 row_mirror row_mask:0xf bank_mask:0x8
    v_add_f32_dpp v53, v48, v48 row_mirror row_mask:0xf bank_mask:0x1
    v_add_f32_dpp v53, v49, v49 row_mirror row_mask:0xf bank_mask:0x2
    v_add_f32_dpp v53, v50, v50 row_mirror row_mask:0xf bank_mask:0x4
    v_add_f32_dpp v53, v51, v51 row_mirror row_mask:0xf bank_mask:0x8
    v_max3_f32 v36, v36, v52, v53
    ds_write2_b32 v54, v52, v53 offset0:0 offset1:4
    s_add_u32 s79, s79, 7
    s_nop 2
    s_cmp_lt_u32 s3, 4
    s_cbranch_scc1 L_K
    s_waitcnt vmcnt(7)
    v_mov_b32 v44, 0
    v_dot2c_f32_bf16 v44, v64, v8
    v_dot2c_f32_bf16 v44, v65, v9
    v_dot2c_f32_bf16 v44, v66, v10
    v_dot2c_f32_bf16 v44, v67, v11
    s_waitcnt vmcnt(6)
    v_mov_b32 v45, 0
    v_dot2c_f32_bf16 v45, v68, v8
    v_dot2c_f32_bf16 v45, v69, v9
    v_dot2c_f32_bf16 v45, v70, v10
    v_dot2c_f32_bf16 v45, v71, v11
    s_waitcnt vmcnt(5)
    v_mov_b32 v46, 0
    v_dot2c_f32_bf16 v46, v72, v8
    v_dot2c_f32_bf16 v46, v73, v9
    v_dot2c_f32_bf16 v46, v74, v10
    v_dot2c_f32_bf16 v46, v75, v11
    s_waitcnt vmcnt(4)
    v_mov_b32 v47, 0
    v_dot2c_f32_bf16 v47, v76, v8
    v_dot2c_f32_bf16 v47, v77, v9
    v_dot2c_f32_bf16 v47, v78, v10
    v_dot2c_f32_bf16 v47, v79, v11
    s_waitcnt vmcnt(3)
    v_mov_b32 v48, 0
    v_dot2c_f32_bf16 v48, v80, v8
    v_dot2c_f32_bf16 v48, v81, v9
    v_dot2c_f32_bf16 v48, v82, v10
    v_dot2c_f32_bf16 v48, v83, v11
    s_waitcnt vmcnt(2)
    v_mov_b32 v49, 0
    v_dot2c_f32_bf16 v49, v84, v8
    v_dot2c_f32_bf16 v49, v85, v9
    v_dot2c_f32_bf16 v49, v86, v10
    v_dot2c_f32_bf16 v49, v87, v11
    s_waitcnt vmcnt(1)
    v_mov_b32 v50, 0
    v_dot2c_f32_bf16 v50, v88, v8
    v_dot2c_f32_bf16 v50, v89, v9
    v_dot2c_f32_bf16 v50, v90, v10
    v_dot2c_f32_bf16 v50, v91, v11
    s_waitcnt vmcnt(0)
    v_mov_b32 v51, 0
    v_dot2c_f32_bf16 v51, v92, v8
    v_dot2c_f32_bf16 v51, v93, v9
    v_dot2c_f32_bf16 v51, v94, v10
    v_dot2c_f32_bf16 v51, v95, v11
    s_lshl_b32 s66, s79, 7
    v_add_u32 v54, s66, v43
    s_nop 1
    v_add_f32_dpp v44, v44, v44 quad_perm:[1,0,3,2] row_mask:0xf bank_mask:0xf
    v_add_f32_dpp v45, v45, v45 quad_perm:[1,0,3,2] row_mask:0xf bank_mask:0xf
    v_add_f32_dpp v46, v46, v46 quad_perm:[1,0,3,2] row_mask:0xf bank_mask:0xf
    v_add_f32_dpp v47, v47, v47 quad_perm:[1,0,3,2] row_mask:0xf bank_mask:0xf
    v_add_f32_dpp v48, v48, v48 quad_perm:[1,0,3,2] row_mask:0xf bank_mask:0xf
    v_add_f32_dpp v49, v49, v49 quad_perm:[1,0,3,2] row_mask:0xf bank_mask:0xf
    v_add_f32_dpp v50, v50, v50 quad_perm:[1,0,3,2] row_mask:0xf bank_mask:0xf
    v_add_f32_dpp v51, v51, v51 quad_perm:[1,0,3,2] row_mask:0xf bank_mask:0xf
    v_add_f32_dpp v44, v44, v44 quad_perm:[2,3,0,1] row_mask:0xf bank_mask:0xf
    v_add_f32_dpp v45, v45, v45 quad_perm:[2,3,0,1] row_mask:0xf bank_mask:0xf
    v_add_f32_dpp v46, v46, v46 quad_perm:[2,3,0,1] row_mask:0xf bank_mask:0xf
    v_add_f32_dpp v47, v47, v47 quad_perm:[2,3,0,1] row_mask:0xf bank_mask:0xf
    v_add_f32_dpp v48, v48, v48 quad_perm:[2,3,0,1] row_mask:0xf bank_mask:0xf
    v_add_f32_dpp v49, v49, v49 quad_perm:[2,3,0,1] row_mask:0xf bank_mask:0xf
    v_add_f32_dpp v50, v50, v50 quad_perm:[2,3,0,1] row_mask:0xf bank_mask:0xf
    v_add_f32_dpp v51, v51, v51 quad_perm:[2,3,0,1] row_mask:0xf bank_mask:0xf
    v_add_f32_dpp v44, v44, v44 row_half_mirror row_mask:0xf bank_mask:0xf
    v_add_f32_dpp v45, v45, v45 row_half_mirror row_mask:0xf bank_mask:0xf
    v_add_f32_dpp v46, v46, v46 row_half_mirror row_mask:0xf bank_mask:0xf
    v_add_f32_dpp v47, v47, v47 row_half_mirror row_mask:0xf bank_mask:0xf
    v_add_f32_dpp v48, v48, v48 row_half_mirror row_mask:0xf bank_mask:0xf
    v_add_f32_dpp v49, v49, v49 row_half_mirror row_mask:0xf bank_mask:0xf
    v_add_f32_dpp v50, v50, v50 row_half_mirror row_mask:0xf bank_mask:0xf
    v_add_f32_dpp v51, v51, v51 row_half_mirror row_mask:0xf bank_mask:0xf
    v_add_f32_dpp v52, v44, v44 row_mirror row_mask:0xf bank_mask:0x1
    v_add_f32_dpp v52, v45, v45 row_mirror row_mask:0xf bank_mask:0x2
    v_add_f32_dpp v52, v46, v46 row_mirror row_mask:0xf bank_mask:0x4
    v_add_f32_dpp v52, v47, v47 row_mirror row_mask:0xf bank_mask:0x8
    v_add_f32_dpp v53, v48, v48 row_mirror row_mask:0xf bank_mask:0x1
    v_add_f32_dpp v53, v49, v49 row_mirror row_mask:0xf bank_mask:0x2
    v_add_f32_dpp v53, v50, v50 row_mirror row_mask:0xf bank_mask:0x4
    v_add_f32_dpp v53, v51, v51 row_mirror row_mask:0xf bank_mask:0x8
    v_max3_f32 v36, v36, v52, v53
    ds_write2_b32 v54, v52, v53 offset0:0 offset1:4
    s_branch L_Ktr
.p2align 12
L_K:
    s_memrealtime s[44:45]
    s_mov_b64 exec, 1
    ds_add_rtn_u32 v6, v3, v4 offset:0
    s_waitcnt lgkmcnt(0)
    v_readfirstlane_b32 s53, v6
    s_nop 3
    s_cmp_eq_u32 s53, 29
    s_cbranch_scc0 L_K_noev1
    s_and_b32 s66, s59, 5
    s_cmp_eq_u32 s66, 0
    s_cbranch_scc0 L_e1x
    s_mov_b64 exec, -1
    s_bfe_u32 s80, s56, 0x80000
    s_bfe_u32 s81, s56, 0x80008
    s_bfe_u32 s82, s56, 0x80010
    s_bfe_u32 s83, s56, 0x80018
    s_lshl_b32 s66, s60, 13
    s_lshl_b32 s67, s59, 11
    s_add_u32 s66, s66, s67
    s_add_u32 s66, s66, 0x100000
    s_lshl_b32 s67, s59, 13
    s_lshl_b32 s68, s60, 9
    s_add_u32 s67, s67, s68
    s_add_u32 s67, s67, 0x10000
    s_mov_b32 s70, 0
L_e1poll:
    buffer_load_dwordx4 v[96:99], v0, s[40:43], s66 offen offset:0 sc1
    buffer_load_dwordx4 v[100:103], v0, s[40:43], s66 offen offset:1024 sc1
    buffer_load_dwordx4 v[104:107], v0, s[40:43], s66 offen offset:2048 sc1
    buffer_load_dwordx4 v[108:111], v0, s[40:43], s66 offen offset:3072 sc1
    s_waitcnt vmcnt(0)
    v_xor_b32 v46, s80, v96
    v_xor_b32 v45, s81, v97
    v_or_b32 v46, v46, v45
    v_xor_b32 v45, s82, v98
    v_or_b32 v46, v46, v45
    v_xor_b32 v45, s83, v99
    v_or_b32 v46, v46, v45
    v_xor_b32 v47, s80, v100
    v_xor_b32 v45, s81, v101
    v_or_b32 v47, v47, v45
    v_xor_b32 v45, s82, v102
    v_or_b32 v47, v47, v45
    v_xor_b32 v45, s83, v103
    v_or_b32 v47, v47, v45
    v_xor_b32 v48, s80, v104
    v_xor_b32 v45, s81, v105
    v_or_b32 v48, v48, v45
    v_xor_b32 v45, s82, v106
    v_or_b32 v48, v48, v45
    v_xor_b32 v45, s83, v107
    v_or_b32 v48, v48, v45
    v_xor_b32 v49, s80, v108
    v_xor_b32 v45, s81, v109
    v_or_b32 v49, v49, v45
    v_xor_b32 v45, s82, v110
    v_or_b32 v49, v49, v45
    v_xor_b32 v45, s83, v111
    v_or_b32 v49, v49, v45
    v_or3_b32 v45, v46, v47, v48
    v_or_b32 v45, v45, v49
    v_and_b32 v45, 0xff, v45
    v_cmp_ne_u32 vcc, 0, v45
    s_cbranch_vccz L_e1ok
    s_add_u32 s70, s70, 1
    s_cmp_lt_u32 s70, 200000
    s_cbranch_scc0 L_e1ok
    s_sleep 8
    s_branch L_e1poll
L_e1ok:
    v_xor_b32 v96, s80, v96
    v_xor_b32 v97, s81, v97
    v_xor_b32 v98, s82, v98
    v_xor_b32 v99, s83, v99
    v_xor_b32 v100, s80, v100
    v_xor_b32 v101, s81, v101
    v_xor_b32 v102, s82, v102
    v_xor_b32 v103, s83, v103
    v_xor_b32 v104, s80, v104
    v_xor_b32 v105, s81, v105
    v_xor_b32 v106, s82, v106
    v_xor_b32 v107, s83, v107
    v_xor_b32 v108, s80, v108
    v_xor_b32 v109, s81, v109
    v_xor_b32 v110, s82, v110
    v_xor_b32 v111, s83, v111
    v_add_f32 v96, v96, v104
    v_add_f32 v97, v97, v105
    v_add_f32 v98, v98, v106
    v_add_f32 v99, v99, v107
    v_add_f32 v100, v100, v108
    v_add_f32 v101, v101, v109
    v_add_f32 v102, v102, v110
    v_add_f32 v103, v103, v111
    v_add_f32 v96, v96, v100
    v_add_f32 v97, v97, v101
    v_add_f32 v98, v98, v102
    v_add_f32 v99, v99, v103
    v_mov_b32 v100, v96
    v_mov_b32 v101, v97
    v_mov_b32 v102, v98
    v_mov_b32 v103, v99
    s_nop 0
    v_permlane32_swap_b32 v96, v100
    v_permlane32_swap_b32 v97, v101
    v_permlane32_swap_b32 v98, v102
    v_permlane32_swap_b32 v99, v103
    v_add_f32 v96, v96, v100
    v_add_f32 v97, v97, v101
    v_add_f32 v98, v98, v102
    v_add_f32 v99, v99, v103
    v_cvt_pk_bf16_f32 v44, v96, v97
    v_cvt_pk_bf16_f32 v45, v98, v99
    v_mov_b32 v46, s56
    v_mov_b32 v47, s56
    s_mov_b32 exec_hi, 0
    buffer_store_dwordx4 v[44:47], v0, s[40:43], s67 offen sc1
    s_mov_b64 exec, 1
    s_nop 0
L_e1x:
L_K_noev1:
    s_mul_i32 s66, s53, s74
    s_lshr_b32 s66, s66, 8
    s_add_u32 s66, s66, s72
    s_sub_u32 s67, s44, s66
    s_cmp_lt_i32 s67, 0
    s_cbranch_scc0 L_pcKx
    s_mov_b32 s70, 0
L_pcK:
    s_sleep 1
    s_memrealtime s[44:45]
    s_waitcnt lgkmcnt(0)
    s_add_u32 s70, s70, 1
    s_cmp_lt_u32 s70, 64
    s_cbranch_scc0 L_pcKx
    s_sub_u32 s67, s44, s66
    s_cmp_lt_i32 s67, 0
    s_cbranch_scc1 L_pcK
L_pcKx:
    s_mov_b64 exec, -1
    s_bfe_u32 s66, s53, 0x20000
    s_lshl_b32 s66, s66, 12
    s_add_u32 s50, s48, s66
    s_bfe_u32 s66, s53, 0x10002
    s_lshl_b32 s66, s66, 18
    s_add_u32 s50, s50, s66
    s_bfe_u32 s66, s53, 0x10003
    s_lshl_b32 s66, s66, 17
    s_add_u32 s50, s50, s66
    s_bfe_u32 s66, s53, 0x10004
    s_lshl_b32 s66, s66, 19
    s_add_u32 s50, s50, s66
    s_bfe_u32 s66, s53, 0x10005
    s_lshl_b32 s66, s66, 14
    s_add_u32 s50, s50, s66
    s_cmp_ge_u32 s53, s26
    s_cselect_b32 s32, s18, s16
    s_cselect_b32 s33, s19, s17
    s_cselect_b32 s36, s18, s16
    s_cselect_b32 s37, s19, s17
    s_waitcnt vmcnt(7)
    v_mov_b32 v44, 0
    v_dot2c_f32_bf16 v44, v64, v8
    v_dot2c_f32_bf16 v44, v65, v9
    v_dot2c_f32_bf16 v44, v66, v10
    v_dot2c_f32_bf16 v44, v67, v11
    buffer_load_dwordx4 v[64:67], v0, s[32:35], s50 offen offset:0 nt
    s_waitcnt vmcnt(7)
    v_mov_b32 v45, 0
    v_dot2c_f32_bf16 v45, v68, v8
    v_dot2c_f32_bf16 v45, v69, v9
    v_dot2c_f32_bf16 v45, v70, v10
    v_dot2c_f32_bf16 v45, v71, v11
    buffer_load_dwordx4 v[68:71], v0, s[32:35], s50 offen offset:1024 nt
    s_waitcnt vmcnt(7)
    v_mov_b32 v46, 0
    v_dot2c_f32_bf16 v46, v72, v8
    v_dot2c_f32_bf16 v46, v73, v9
    v_dot2c_f32_bf16 v46, v74, v10
    v_dot2c_f32_bf16 v46, v75, v11
    buffer_load_dwordx4 v[72:75], v0, s[32:35], s50 offen offset:2048 nt
    s_waitcnt vmcnt(7)
    v_mov_b32 v47, 0
    v_dot2c_f32_bf16 v47, v76, v8
    v_dot2c_f32_bf16 v47, v77, v9
    v_dot2c_f32_bf16 v47, v78, v10
    v_dot2c_f32_bf16 v47, v79, v11
    buffer_load_dwordx4 v[76:79], v0, s[32:35], s50 offen offset:3072 nt
    s_waitcnt vmcnt(7)
    v_mov_b32 v48, 0
    v_dot2c_f32_bf16 v48, v80, v8
    v_dot2c_f32_bf16 v48, v81, v9
    v_dot2c_f32_bf16 v48, v82, v10
    v_dot2c_f32_bf16 v48, v83, v11
    buffer_load_dwordx4 v[80:83], v42, s[36:39], s50 offen offset:0 nt
    s_waitcnt vmcnt(7)
    v_mov_b32 v49, 0
    v_dot2c_f32_bf16 v49, v84, v8
    v_dot2c_f32_bf16 v49, v85, v9
    v_dot2c_f32_bf16 v49, v86, v10
    v_dot2c_f32_bf16 v49, v87, v11
    buffer_load_dwordx4 v[84:87], v42, s[36:39], s50 offen offset:1024 nt
    s_waitcnt vmcnt(7)
    v_mov_b32 v50, 0
    v_dot2c_f32_bf16 v50, v88, v8
    v_dot2c_f32_bf16 v50, v89, v9
    v_dot2c_f32_bf16 v50, v90, v10
    v_dot2c_f32_bf16 v50, v91, v11
    buffer_load_dwordx4 v[88:91], v42, s[36:39], s50 offen offset:2048 nt
    s_waitcnt vmcnt(7)
    v_mov_b32 v51, 0
    v_dot2c_f32_bf16 v51, v92, v8
    v_dot2c_f32_bf16 v51, v93, v9
    v_dot2c_f32_bf16 v51, v94, v10
    v_dot2c_f32_bf16 v51, v95, v11
    buffer_load_dwordx4 v[92:95], v42, s[36:39], s50 offen offset:3072 nt
    s_lshl_b32 s66, s79, 7
    v_add_u32 v54, s66, v43
    s_nop 1
    v_add_f32_dpp v44, v44, v44 quad_perm:[1,0,3,2] row_mask:0xf bank_mask:0xf
    v_add_f32_dpp v45, v45, v45 quad_perm:[1,0,3,2] row_mask:0xf bank_mask:0xf
    v_add_f32_dpp v46, v46, v46 quad_perm:[1,0,3,2] row_mask:0xf bank_mask:0xf
    v_add_f32_dpp v47, v47, v47 quad_perm:[1,0,3,2] row_mask:0xf bank_mask:0xf
    v_add_f32_dpp v48, v48, v48 quad_perm:[1,0,3,2] row_mask:0xf bank_mask:0xf
    v_add_f32_dpp v49, v49, v49 quad_perm:[1,0,3,2] row_mask:0xf bank_mask:0xf
    v_add_f32_dpp v50, v50, v50 quad_perm:[1,0,3,2] row_mask:0xf bank_mask:0xf
    v_add_f32_dpp v51, v51, v51 quad_perm:[1,0,3,2] row_mask:0xf bank_mask:0xf
    v_add_f32_dpp v44, v44, v44 quad_perm:[2,3,0,1] row_mask:0xf bank_mask:0xf
    v_add_f32_dpp v45, v45, v45 quad_perm:[2,3,0,1] row_mask:0xf bank_mask:0xf
    v_add_f32_dpp v46, v46, v46 quad_perm:[2,3,0,1] row_mask:0xf bank_mask:0xf
    v_add_f32_dpp v47, v47, v47 quad_perm:[2,3,0,1] row_mask:0xf bank_mask:0xf
    v_add_f32_dpp v48, v48, v48 quad_perm:[2,3,0,1] row_mask:0xf bank_mask:0xf
    v_add_f32_dpp v49, v49, v49 quad_perm:[2,3,0,1] row_mask:0xf bank_mask:0xf
    v_add_f32_dpp v50, v50, v50 quad_perm:[2,3,0,1] row_mask:0xf bank_mask:0xf
    v_add_f32_dpp v51, v51, v51 quad_perm:[2,3,0,1] row_mask:0xf bank_mask:0xf
    v_add_f32_dpp v44, v44, v44 row_half_mirror row_mask:0xf bank_mask:0xf
    v_add_f32_dpp v45, v45, v45 row_half_mirror row_mask:0xf bank_mask:0xf
    v_add_f32_dpp v46, v46, v46 row_half_mirror row_mask:0xf bank_mask:0xf
    v_add_f32_dpp v47, v47, v47 row_half_mirror row_mask:0xf bank_mask:0xf
    v_add_f32_dpp v48, v48, v48 row_half_mirror row_mask:0xf bank_mask:0xf
    v_add_f32_dpp v49, v49, v49 row_half_mirror row_mask:0xf bank_mask:0xf
    v_add_f32_dpp v50, v50, v50 row_half_mirror row_mask:0xf bank_mask:0xf
    v_add_f32_dpp v51, v51, v51 row_half_mirror row_mask:0xf bank_mask:0xf
    v_add_f32_dpp v52, v44, v44 row_mirror row_mask:0xf bank_mask:0x1
    v_add_f32_dpp v52, v45, v45 row_mirror row_mask:0xf bank_mask:0x2
    v_add_f32_dpp v52, v46, v46 row_mirror row_mask:0xf bank_mask:0x4
    v_add_f32_dpp v52, v47, v47 row_mirror row_mask:0xf bank_mask:0x8
    v_add_f32_dpp v53, v48, v48 row_mirror row_mask:0xf bank_mask:0x1
    v_add_f32_dpp v53, v49, v49 row_mirror row_mask:0xf bank_mask:0x2
    v_add_f32_dpp v53, v50, v50 row_mirror row_mask:0xf bank_mask:0x4
    v_add_f32_dpp v53, v51, v51 row_mirror row_mask:0xf bank_mask:0x8
    v_max3_f32 v36, v36, v52, v53
    ds_write2_b32 v54, v52, v53 offset0:0 offset1:4
    s_mov_b32 s79, s53
    s_cmp_lt_u32 s79, s26
    s_cbranch_scc1 L_K
L_Ktr:
    v_lshlrev_b32 v44, 2, v1
    ds_write2st64_b32 v44, v3, v3 offset0:109 offset1:110
    ds_write_b32 v44, v3 offset:28416
    s_mov_b32 exec_lo, 0x11111111
    s_mov_b32 exec_hi, 0x11111111
    ds_max_f32 v3, v36 offset:24
    s_mov_b64 exec, -1
    s_waitcnt lgkmcnt(0)
    s_barrier
    ds_read_b32 v36, v3 offset:24
    s_waitcnt lgkmcnt(0)
    v_mul_f32 v38, s58, v36
    s_cmp_lt_u32 s3, 4
    s_cbranch_scc1 L_B
    s_mov_b32 s55, 2
    s_mov_b32 s78, 0
    s_branch L_idle
L_B:
    s_memrealtime s[44:45]
    s_mov_b64 exec, 1
    ds_add_rtn_u32 v6, v3, v4 offset:0
    s_mov_b64 exec, -1
    s_sub_u32 s66, s79, s26
    s_lshl_b32 s66, s66, 7
    v_add_u32 v140, s66, v251
    ds_read_b128 v[132:135], v140
    ds_read_b128 v[136:139], v140 offset:16
    s_waitcnt lgkmcnt(1)
    v_fma_f32 v132, v132, s58, -v38
    v_fma_f32 v133, v133, s58, -v38
    v_fma_f32 v134, v134, s58, -v38
    v_fma_f32 v135, v135, s58, -v38
    s_waitcnt lgkmcnt(0)
    v_fma_f32 v136, v136, s58, -v38
    v_fma_f32 v137, v137, s58, -v38
    v_fma_f32 v138, v138, s58, -v38
    v_fma_f32 v139, v139, s58, -v38
    v_exp_f32 v132, v132
    v_exp_f32 v133, v133
    v_exp_f32 v134, v134
    v_exp_f32 v135, v135
    v_exp_f32 v136, v136
    v_exp_f32 v137, v137
    v_exp_f32 v138, v138
    v_exp_f32 v139, v139
    s_nop 0
    v_cvt_pk_bf16_f32 v140, v132, 0
    v_cvt_pk_bf16_f32 v141, v133, 0
    v_cvt_pk_bf16_f32 v142, v134, 0
    v_cvt_pk_bf16_f32 v143, v135, 0
    v_cvt_pk_bf16_f32 v144, v136, 0
    v_cvt_pk_bf16_f32 v145, v137, 0
    v_cvt_pk_bf16_f32 v146, v138, 0
    v_cvt_pk_bf16_f32 v147, v139, 0
    v_lshlrev_b32 v132, 16, v140
    v_lshlrev_b32 v133, 16, v141
    v_lshlrev_b32 v134, 16, v142
    v_lshlrev_b32 v135, 16, v143
    v_lshlrev_b32 v136, 16, v144
    v_lshlrev_b32 v137, 16, v145
    v_lshlrev_b32 v138, 16, v146
    v_lshlrev_b32 v139, 16, v147
    v_add_f32 v44, v132, v133
    v_add_f32 v45, v134, v135
    v_add_f32 v46, v136, v137
    v_add_f32 v47, v138, v139
    v_add_f32 v44, v44, v45
    v_add_f32 v46, v46, v47
    v_add_f32 v40, v40, v44
    v_add_f32 v40, v40, v46
    v_readfirstlane_b32 s53, v6
    s_mov_b64 exec, 1
    s_nop 2
    s_cmp_eq_u32 s53, 90
    s_cbranch_scc0 L_B_noev
    s_mov_b64 exec, -1
    s_lshl_b32 s66, s60, 10
    s_add_u32 s66, s66, 0x10000
    s_mov_b32 s67, 0x8000
    s_mov_b32 s70, 0
L_evpoll:
    buffer_load_dwordx4 v[96:99], v0, s[40:43], s66 offen sc1
    buffer_load_dwordx4 v[100:103], v0, s[40:43], s67 offen sc1
    s_waitcnt vmcnt(0)
    v_xor_b32 v98, s56, v98
    v_xor_b32 v99, s56, v99
    v_xor_b32 v100, s56, v100
    v_xor_b32 v101, s56, v101
    v_xor_b32 v102, s56, v102
    v_xor_b32 v103, s56, v103
    v_or3_b32 v45, v98, v99, v100
    v_or3_b32 v46, v101, v102, v103
    v_or_b32 v45, v45, v46
    v_cmp_ne_u32 vcc, 0, v45
    s_cbranch_vccz L_evok
    s_add_u32 s70, s70, 1
    s_cmp_lt_u32 s70, 200000
    s_cbranch_scc0 L_evok
    s_sleep 8
    s_branch L_evpoll
L_evok:
    v_lshlrev_b32 v44, 3, v1
    ds_write_b64 v44, v[96:97] offset:512
    s_mov_b64 exec, 1
    s_waitcnt lgkmcnt(0)
    ds_write_b32 v3, v4 offset:12
    s_cmp_eq_u32 s2, 0
    s_cbranch_scc0 L_ev_noep
    v_mov_b32 v45, s56
    buffer_store_dword v45, v3, s[40:43], 0 offen sc1
L_ev_noep:
L_B_noev:
    s_cmp_lt_u32 s53, s27
    s_cbranch_scc0 L_B_r1
    s_mul_i32 s66, s53, s74
    s_lshr_b32 s66, s66, 8
    s_add_u32 s66, s66, s72
    s_sub_u32 s67, s44, s66
    s_cmp_lt_i32 s67, 0
    s_cbranch_scc0 L_pcVx
    s_mov_b32 s70, 0
L_pcV:
    s_sleep 1
    s_memrealtime s[44:45]
    s_waitcnt lgkmcnt(0)
    s_add_u32 s70, s70, 1
    s_cmp_lt_u32 s70, 64
    s_cbranch_scc0 L_pcVx
    s_sub_u32 s67, s44, s66
    s_cmp_lt_i32 s67, 0
    s_cbranch_scc1 L_pcV
L_pcVx:
    s_bfe_u32 s66, s53, 0x20000
    s_lshl_b32 s66, s66, 12
    s_add_u32 s50, s48, s66
    s_bfe_u32 s66, s53, 0x10002
    s_lshl_b32 s66, s66, 18
    s_add_u32 s50, s50, s66
    s_bfe_u32 s66, s53, 0x10003
    s_lshl_b32 s66, s66, 17
    s_add_u32 s50, s50, s66
    s_bfe_u32 s66, s53, 0x10004
    s_lshl_b32 s66, s66, 19
    s_add_u32 s50, s50, s66
    s_bfe_u32 s66, s53, 0x10005
    s_lshl_b32 s66, s66, 14
    s_add_u32 s50, s50, s66
    s_mov_b32 s79, s53
    s_mov_b32 s55, 0
    s_mov_b64 exec, -1
    s_waitcnt vmcnt(7)
    v_dot2c_f32_bf16 v20, v64, v140
    v_dot2c_f32_bf16 v21, v64, v132
    v_dot2c_f32_bf16 v22, v65, v140
    v_dot2c_f32_bf16 v23, v65, v132
    v_dot2c_f32_bf16 v24, v66, v140
    v_dot2c_f32_bf16 v25, v66, v132
    v_dot2c_f32_bf16 v26, v67, v140
    v_dot2c_f32_bf16 v27, v67, v132
    buffer_load_dwordx4 v[64:67], v0, s[32:35], s50 offen offset:0 nt
    s_waitcnt vmcnt(7)
    v_dot2c_f32_bf16 v20, v68, v141
    v_dot2c_f32_bf16 v21, v68, v133
    v_dot2c_f32_bf16 v22, v69, v141
    v_dot2c_f32_bf16 v23, v69, v133
    v_dot2c_f32_bf16 v24, v70, v141
    v_dot2c_f32_bf16 v25, v70, v133
    v_dot2c_f32_bf16 v26, v71, v141
    v_dot2c_f32_bf16 v27, v71, v133
    buffer_load_dwordx4 v[68:71], v0, s[32:35], s50 offen offset:1024 nt
    s_waitcnt vmcnt(7)
    v_dot2c_f32_bf16 v20, v72, v142
    v_dot2c_f32_bf16 v21, v72, v134
    v_dot2c_f32_bf16 v22, v73, v142
    v_dot2c_f32_bf16 v23, v73, v134
    v_dot2c_f32_bf16 v24, v74, v142
    v_dot2c_f32_bf16 v25, v74, v134
    v_dot2c_f32_bf16 v26, v75, v142
    v_dot2c_f32_bf16 v27, v75, v134
    buffer_load_dwordx4 v[72:75], v0, s[32:35], s50 offen offset:2048 nt
    s_waitcnt vmcnt(7)
    v_dot2c_f32_bf16 v20, v76, v143
    v_dot2c_f32_bf16 v21, v76, v135
    v_dot2c_f32_bf16 v22, v77, v143
    v_dot2c_f32_bf16 v23, v77, v135
    v_dot2c_f32_bf16 v24, v78, v143
    v_dot2c_f32_bf16 v25, v78, v135
    v_dot2c_f32_bf16 v26, v79, v143
    v_dot2c_f32_bf16 v27, v79, v135
    buffer_load_dwordx4 v[76:79], v0, s[32:35], s50 offen offset:3072 nt
    s_waitcnt vmcnt(7)
    v_dot2c_f32_bf16 v20, v80, v144
    v_dot2c_f32_bf16 v21, v80, v136
    v_dot2c_f32_bf16 v22, v81, v144
    v_dot2c_f32_bf16 v23, v81, v136
    v_dot2c_f32_bf16 v24, v82, v144
    v_dot2c_f32_bf16 v25, v82, v136
    v_dot2c_f32_bf16 v26, v83, v144
    v_dot2c_f32_bf16 v27, v83, v136
    buffer_load_dwordx4 v[80:83], v42, s[36:39], s50 offen offset:0 nt
    s_waitcnt vmcnt(7)
    v_dot2c_f32_bf16 v20, v84, v145
    v_dot2c_f32_bf16 v21, v84, v137
    v_dot2c_f32_bf16 v22, v85, v145
    v_dot2c_f32_bf16 v23, v85, v137
    v_dot2c_f32_bf16 v24, v86, v145
    v_dot2c_f32_bf16 v25, v86, v137
    v_dot2c_f32_bf16 v26, v87, v145
    v_dot2c_f32_bf16 v27, v87, v137
    buffer_load_dwordx4 v[84:87], v42, s[36:39], s50 offen offset:1024 nt
    s_waitcnt vmcnt(7)
    v_dot2c_f32_bf16 v20, v88, v146
    v_dot2c_f32_bf16 v21, v88, v138
    v_dot2c_f32_bf16 v22, v89, v146
    v_dot2c_f32_bf16 v23, v89, v138
    v_dot2c_f32_bf16 v24, v90, v146
    v_dot2c_f32_bf16 v25, v90, v138
    v_dot2c_f32_bf16 v26, v91, v146
    v_dot2c_f32_bf16 v27, v91, v138
    buffer_load_dwordx4 v[88:91], v42, s[36:39], s50 offen offset:2048 nt
    s_waitcnt vmcnt(7)
    v_dot2c_f32_bf16 v20, v92, v147
    v_dot2c_f32_bf16 v21, v92, v139
    v_dot2c_f32_bf16 v22, v93, v147
    v_dot2c_f32_bf16 v23, v93, v139
    v_dot2c_f32_bf16 v24, v94, v147
    v_dot2c_f32_bf16 v25, v94, v139
    v_dot2c_f32_bf16 v26, v95, v147
    v_dot2c_f32_bf16 v27, v95, v139
    buffer_load_dwordx4 v[92:95], v42, s[36:39], s50 offen offset:3072 nt
    s_branch L_B
L_B_rd:
    s_mov_b32 s55, 2
    s_waitcnt vmcnt(7)
    v_dot2c_f32_bf16 v20, v64, v140
    v_dot2c_f32_bf16 v21, v64, v132
    v_dot2c_f32_bf16 v22, v65, v140
    v_dot2c_f32_bf16 v23, v65, v132
    v_dot2c_f32_bf16 v24, v66, v140
    v_dot2c_f32_bf16 v25, v66, v132
    v_dot2c_f32_bf16 v26, v67, v140
    v_dot2c_f32_bf16 v27, v67, v132
    s_waitcnt vmcnt(6)
    v_dot2c_f32_bf16 v20, v68, v141
    v_dot2c_f32_bf16 v21, v68, v133
    v_dot2c_f32_bf16 v22, v69, v141
    v_dot2c_f32_bf16 v23, v69, v133
    v_dot2c_f32_bf16 v24, v70, v141
    v_dot2c_f32_bf16 v25, v70, v133
    v_dot2c_f32_bf16 v26, v71, v141
    v_dot2c_f32_bf16 v27, v71, v133
    s_waitcnt vmcnt(5)
    v_dot2c_f32_bf16 v20, v72, v142
    v_dot2c_f32_bf16 v21, v72, v134
    v_dot2c_f32_bf16 v22, v73, v142
    v_dot2c_f32_bf16 v23, v73, v134
    v_dot2c_f32_bf16 v24, v74, v142
    v_dot2c_f32_bf16 v25, v74, v134
    v_dot2c_f32_bf16 v26, v75, v142
    v_dot2c_f32_bf16 v27, v75, v134
    s_waitcnt vmcnt(4)
    v_dot2c_f32_bf16 v20, v76, v143
    v_dot2c_f32_bf16 v21, v76, v135
    v_dot2c_f32_bf16 v22, v77, v143
    v_dot2c_f32_bf16 v23, v77, v135
    v_dot2c_f32_bf16 v24, v78, v143
    v_dot2c_f32_bf16 v25, v78, v135
    v_dot2c_f32_bf16 v26, v79, v143
    v_dot2c_f32_bf16 v27, v79, v135
    s_waitcnt vmcnt(3)
    v_dot2c_f32_bf16 v20, v80, v144
    v_dot2c_f32_bf16 v21, v80, v136
    v_dot2c_f32_bf16 v22, v81, v144
    v_dot2c_f32_bf16 v23, v81, v136
    v_dot2c_f32_bf16 v24, v82, v144
    v_dot2c_f32_bf16 v25, v82, v136
    v_dot2c_f32_bf16 v26, v83, v144
    v_dot2c_f32_bf16 v27, v83, v136
    s_waitcnt vmcnt(2)
    v_dot2c_f32_bf16 v20, v84, v145
    v_dot2c_f32_bf16 v21, v84, v137
    v_dot2c_f32_bf16 v22, v85, v145
    v_dot2c_f32_bf16 v23, v85, v137
    v_dot2c_f32_bf16 v24, v86, v145
    v_dot2c_f32_bf16 v25, v86, v137
    v_dot2c_f32_bf16 v26, v87, v145
    v_dot2c_f32_bf16 v27, v87, v137
    s_waitcnt vmcnt(1)
    v_dot2c_f32_bf16 v20, v88, v146
    v_dot2c_f32_bf16 v21, v88, v138
    v_dot2c_f32_bf16 v22, v89, v146
    v_dot2c_f32_bf16 v23, v89, v138
    v_dot2c_f32_bf16 v24, v90, v146
    v_dot2c_f32_bf16 v25, v90, v138
    v_dot2c_f32_bf16 v26, v91, v146
    v_dot2c_f32_bf16 v27, v91, v138
    s_waitcnt vmcnt(0)
    v_dot2c_f32_bf16 v20, v92, v147
    v_dot2c_f32_bf16 v21, v92, v139
    v_dot2c_f32_bf16 v22, v93, v147
    v_dot2c_f32_bf16 v23, v93, v139
    v_dot2c_f32_bf16 v24, v94, v147
    v_dot2c_f32_bf16 v25, v94, v139
    v_dot2c_f32_bf16 v26, v95, v147
    v_dot2c_f32_bf16 v27, v95, v139
    s_branch L_B_out
.p2align 12
L_B_r1:
    s_setprio 3
    s_mov_b32 s70, 0
L_qawb:
    ds_read_b32 v6, v3 offset:12
    s_waitcnt lgkmcnt(0)
    v_readfirstlane_b32 s66, v6
    s_nop 3
    s_cmp_eq_u32 s66, 1
    s_cbranch_scc1 L_qaokb
    s_add_u32 s70, s70, 1
    s_cmp_lt_u32 s70, 800000
    s_cbranch_scc0 L_qaokb
    s_sleep 8
    s_branch L_qawb
L_qaokb:
    s_mov_b64 exec, -1
    v_lshrrev_b32 v44, 4, v1
    v_lshlrev_b32 v44, 5, v44
    v_and_b32 v45, 1, v1
    v_lshl_add_u32 v44, v45, 4, v44
    v_bfe_u32 v46, v1, 1, 1
    v_lshl_add_u32 v44, v46, 8, v44
    ds_read_b128 v[148:151], v44 offset:512
    ds_read_b128 v[152:155], v44 offset:640
    v_cmp_eq_u32 vcc, 1, v45
    v_mov_b32 v46, 0xffff
    v_mov_b32 v47, 0xffff0000
    v_cndmask_b32 v46, v46, v47, vcc
    v_bfe_u32 v47, v1, 1, 2
    v_cmp_eq_u32 vcc, 0, v47
    s_nop 1
    v_cndmask_b32 v164, 0, v46, vcc
    v_cmp_eq_u32 vcc, 1, v47
    s_nop 1
    v_cndmask_b32 v165, 0, v46, vcc
    v_cmp_eq_u32 vcc, 2, v47
    s_nop 1
    v_cndmask_b32 v166, 0, v46, vcc
    v_cmp_eq_u32 vcc, 3, v47
    s_nop 1
    v_cndmask_b32 v167, 0, v46, vcc
    v_and_b32 v45, 3, v1
    v_lshlrev_b32 v188, 10, v45
    v_bfe_u32 v45, v1, 2, 1
    v_lshl_add_u32 v188, v45, 8, v188
    v_lshrrev_b32 v45, 3, v1
    v_lshl_add_u32 v188, v45, 4, v188
    s_mov_b32 vcc_lo, 0xff00ff00
    s_mov_b32 vcc_hi, 0xff00ff00
    s_waitcnt lgkmcnt(0)
    v_cndmask_b32 v156, 0, v148, vcc
    v_cndmask_b32 v157, 0, v149, vcc
    v_cndmask_b32 v158, 0, v150, vcc
    v_cndmask_b32 v159, 0, v151, vcc
    v_cndmask_b32 v160, 0, v152, vcc
    v_cndmask_b32 v161, 0, v153, vcc
    v_cndmask_b32 v162, 0, v154, vcc
    v_cndmask_b32 v163, 0, v155, vcc
    s_mov_b64 exec, vcc
    v_mov_b32 v148, 0
    v_mov_b32 v149, 0
    v_mov_b32 v150, 0
    v_mov_b32 v151, 0
    v_mov_b32 v152, 0
    v_mov_b32 v153, 0
    v_mov_b32 v154, 0
    v_mov_b32 v155, 0
    s_mov_b64 exec, 1
    s_mov_b32 s32, s6
    s_mov_b32 s33, s7
    s_mov_b32 s34, 67108864
    s_mov_b32 s35, 0x20000
    s_mov_b32 s36, s8
    s_mov_b32 s37, s9
    s_mov_b32 s38, 67108864
    s_mov_b32 s39, 0x20000
    s_mov_b64 exec, 1
    ds_add_rtn_u32 v6, v3, v4 offset:48
    s_mov_b32 s70, 0
    s_waitcnt lgkmcnt(0)
    v_readfirstlane_b32 s53, v6
    v_lshlrev_b32 v6, 2, v6
L_B_q:
    s_memrealtime s[44:45]
    ds_read_b32 v5, v6 offset:27904
    s_add_u32 s70, s70, 1
    s_waitcnt lgkmcnt(0)
    v_readfirstlane_b32 s66, v5
    s_cmp_lt_u32 s70, 3200000
    s_cbranch_scc0 L_B_qx
    s_nop 1
    s_cmp_eq_u32 s66, 0
    s_cbranch_scc1 L_B_q
L_B_qx:
    s_mov_b64 exec, -1
    s_sub_u32 s66, s66, 1
    s_min_u32 s53, s53, s77
    s_cmp_lt_u32 s66, 128
    s_cbranch_scc0 L_B_rd
    s_lshl_b32 s66, s66, 12
    s_add_u32 s50, s66, s49
    s_mov_b32 s55, 1
    s_add_u32 s72, s72, 3580
    s_bitcmp1_b32 s59, 0
    s_mov_b32 s74, 8000
    s_cselect_b32 s74, 8000, s74
    s_sub_u32 s77, s77, 2
    s_mul_i32 s66, s53, s74
    s_lshr_b32 s66, s66, 8
    s_add_u32 s66, s66, s72
    s_sub_u32 s67, s44, s66
    s_cmp_lt_i32 s67, 0
    s_cbranch_scc0 L_pcAx
    s_mov_b32 s70, 0
L_pcA:
    s_sleep 1
    s_memrealtime s[44:45]
    s_waitcnt lgkmcnt(0)
    s_add_u32 s70, s70, 1
    s_cmp_lt_u32 s70, 64
    s_cbranch_scc0 L_pcAx
    s_sub_u32 s67, s44, s66
    s_cmp_lt_i32 s67, 0
    s_cbranch_scc1 L_pcA
L_pcAx:
    s_mov_b64 exec, 1
    ds_add_u32 v3, v4 offset:28668
    s_mov_b64 exec, -1
    s_waitcnt vmcnt(7)
    v_dot2c_f32_bf16 v20, v64, v140
    v_dot2c_f32_bf16 v21, v64, v132
    v_dot2c_f32_bf16 v22, v65, v140
    v_dot2c_f32_bf16 v23, v65, v132
    v_dot2c_f32_bf16 v24, v66, v140
    v_dot2c_f32_bf16 v25, v66, v132
    v_dot2c_f32_bf16 v26, v67, v140
    v_dot2c_f32_bf16 v27, v67, v132
    buffer_load_dwordx4 v[64:67], v188, s[32:35], s50 offen offset:0 nt
    s_waitcnt vmcnt(7)
    v_dot2c_f32_bf16 v20, v68, v141
    v_dot2c_f32_bf16 v21, v68, v133
    v_dot2c_f32_bf16 v22, v69, v141
    v_dot2c_f32_bf16 v23, v69, v133
    v_dot2c_f32_bf16 v24, v70, v141
    v_dot2c_f32_bf16 v25, v70, v133
    v_dot2c_f32_bf16 v26, v71, v141
    v_dot2c_f32_bf16 v27, v71, v133
    buffer_load_dwordx4 v[68:71], v188, s[32:35], s50 offen offset:128 nt
    s_waitcnt vmcnt(7)
    v_dot2c_f32_bf16 v20, v72, v142
    v_dot2c_f32_bf16 v21, v72, v134
    v_dot2c_f32_bf16 v22, v73, v142
    v_dot2c_f32_bf16 v23, v73, v134
    v_dot2c_f32_bf16 v24, v74, v142
    v_dot2c_f32_bf16 v25, v74, v134
    v_dot2c_f32_bf16 v26, v75, v142
    v_dot2c_f32_bf16 v27, v75, v134
    buffer_load_dwordx4 v[72:75], v188, s[32:35], s50 offen offset:512 nt
    s_waitcnt vmcnt(7)
    v_dot2c_f32_bf16 v20, v76, v143
    v_dot2c_f32_bf16 v21, v76, v135
    v_dot2c_f32_bf16 v22, v77, v143
    v_dot2c_f32_bf16 v23, v77, v135
    v_dot2c_f32_bf16 v24, v78, v143
    v_dot2c_f32_bf16 v25, v78, v135
    v_dot2c_f32_bf16 v26, v79, v143
    v_dot2c_f32_bf16 v27, v79, v135
    buffer_load_dwordx4 v[76:79], v188, s[32:35], s50 offen offset:640 nt
    s_waitcnt vmcnt(7)
    v_dot2c_f32_bf16 v20, v80, v144
    v_dot2c_f32_bf16 v21, v80, v136
    v_dot2c_f32_bf16 v22, v81, v144
    v_dot2c_f32_bf16 v23, v81, v136
    v_dot2c_f32_bf16 v24, v82, v144
    v_dot2c_f32_bf16 v25, v82, v136
    v_dot2c_f32_bf16 v26, v83, v144
    v_dot2c_f32_bf16 v27, v83, v136
    buffer_load_dwordx4 v[80:83], v0, s[36:39], s50 offen offset:0 nt
    s_waitcnt vmcnt(7)
    v_dot2c_f32_bf16 v20, v84, v145
    v_dot2c_f32_bf16 v21, v84, v137
    v_dot2c_f32_bf16 v22, v85, v145
    v_dot2c_f32_bf16 v23, v85, v137
    v_dot2c_f32_bf16 v24, v86, v145
    v_dot2c_f32_bf16 v25, v86, v137
    v_dot2c_f32_bf16 v26, v87, v145
    v_dot2c_f32_bf16 v27, v87, v137
    buffer_load_dwordx4 v[84:87], v0, s[36:39], s50 offen offset:1024 nt
    s_waitcnt vmcnt(7)
    v_dot2c_f32_bf16 v20, v88, v146
    v_dot2c_f32_bf16 v21, v88, v138
    v_dot2c_f32_bf16 v22, v89, v146
    v_dot2c_f32_bf16 v23, v89, v138
    v_dot2c_f32_bf16 v24, v90, v146
    v_dot2c_f32_bf16 v25, v90, v138
    v_dot2c_f32_bf16 v26, v91, v146
    v_dot2c_f32_bf16 v27, v91, v138
    buffer_load_dwordx4 v[88:91], v0, s[36:39], s50 offen offset:2048 nt
    s_waitcnt vmcnt(7)
    v_dot2c_f32_bf16 v20, v92, v147
    v_dot2c_f32_bf16 v21, v92, v139
    v_dot2c_f32_bf16 v22, v93, v147
    v_dot2c_f32_bf16 v23, v93, v139
    v_dot2c_f32_bf16 v24, v94, v147
    v_dot2c_f32_bf16 v25, v94, v139
    v_dot2c_f32_bf16 v26, v95, v147
    v_dot2c_f32_bf16 v27, v95, v139
    buffer_load_dwordx4 v[92:95], v0, s[36:39], s50 offen offset:3072 nt
L_B_out:
    v_mov_b32 v44, v38
    v_mov_b32 v45, v38
    v_and_b32 v52, 15, v1
    v_lshlrev_b32 v52, 5, v52
    v_permlane32_swap_b32 v44, v45
    v_max_f32 v44, v44, v45
    v_mov_b32 v45, v44
    v_lshrrev_b32 v53, 4, v1
    v_lshl_add_u32 v52, v53, 3, v52
    v_permlane16_swap_b32 v44, v45
    v_max_f32 v44, v44, v45
    v_sub_f32 v45, v38, v44
    v_exp_f32 v45, v45
    s_lshl_b32 s66, s3, 9
    v_add_u32 v52, s66, v52
    v_mul_f32 v20, v20, v45
    v_mul_f32 v21, v21, v45
    v_mul_f32 v22, v22, v45
    v_mul_f32 v23, v23, v45
    v_mul_f32 v24, v24, v45
    v_mul_f32 v25, v25, v45
    v_mul_f32 v26, v26, v45
    v_mul_f32 v27, v27, v45
    v_mul_f32 v45, v40, v45
    v_mov_b32 v48, v45
    v_permlane32_swap_b32 v20, v24
    v_permlane32_swap_b32 v21, v25
    v_permlane32_swap_b32 v22, v26
    v_permlane32_swap_b32 v23, v27
    v_permlane32_swap_b32 v45, v48
    v_add_f32 v45, v45, v48
    v_mov_b32 v48, v45
    v_add_f32 v20, v20, v24
    v_add_f32 v21, v21, v25
    v_add_f32 v22, v22, v26
    v_add_f32 v23, v23, v27
    s_lshl_b32 s66, s3, 3
    v_mov_b32 v53, s66
    v_permlane16_swap_b32 v45, v48
    v_permlane16_swap_b32 v20, v22
    v_permlane16_swap_b32 v21, v23
    v_add_f32 v20, v20, v22
    v_add_f32 v21, v21, v23
    v_add_f32 v45, v45, v48
    ds_write_b64 v52, v[20:21] offset:1024
    v_lshlrev_b32 v60, 3, v1
    s_mov_b64 exec, 1
    ds_write_b64 v53, v[44:45] offset:256
    ds_add_rtn_u32 v6, v3, v4 offset:4
    s_mov_b64 exec, -1
    ds_read_b128 v[44:47], v3 offset:256
    ds_read_b128 v[48:51], v3 offset:272
    ds_read_b64 v[20:21], v60 offset:1024
    ds_read_b64 v[22:23], v60 offset:1536
    ds_read_b64 v[24:25], v60 offset:2048
    ds_read_b64 v[26:27], v60 offset:2560
    s_lshl_b32 s66, s31, 11
    s_lshl_b32 s68, s51, 8
    s_add_u32 s66, s66, s68
    s_and_b32 s68, s61, 3
    s_lshl_b32 s68, s68, 6
    s_add_u32 s66, s66, s68
    s_add_u32 s66, s66, 0x30000
    s_mul_i32 s67, s31, 256
    s_lshl_b32 s68, s51, 5
    s_add_u32 s67, s67, s68
    s_and_b32 s68, s61, 3
    s_lshl_b32 s68, s68, 3
    s_add_u32 s67, s67, s68
    s_add_u32 s67, s67, 0x40000
    v_lshrrev_b32 v60, 4, v1
    v_lshlrev_b32 v60, 9, v60
    v_bfe_u32 v61, v1, 2, 2
    v_lshl_add_u32 v60, v61, 4, v60
    s_waitcnt lgkmcnt(6)
    v_readfirstlane_b32 s68, v6
    s_waitcnt lgkmcnt(4)
    s_nop 1
    s_cmp_eq_u32 s68, 3
    s_cbranch_scc0 L_fB_skip
    v_max3_f32 v62, v44, v46, v48
    v_max_f32 v62, v62, v50
    v_sub_f32 v44, v44, v62
    v_sub_f32 v46, v46, v62
    v_sub_f32 v48, v48, v62
    v_sub_f32 v50, v50, v62
    v_exp_f32 v44, v44
    v_exp_f32 v46, v46
    v_exp_f32 v48, v48
    v_exp_f32 v50, v50
    s_waitcnt lgkmcnt(0)
    v_mul_f32 v20, v44, v20
    v_mul_f32 v21, v44, v21
    v_mul_f32 v63, v44, v45
    v_fmac_f32 v20, v46, v22
    v_fmac_f32 v21, v46, v23
    v_fmac_f32 v63, v46, v47
    v_fmac_f32 v20, v48, v24
    v_fmac_f32 v21, v48, v25
    v_fmac_f32 v63, v48, v49
    v_fmac_f32 v20, v50, v26
    v_fmac_f32 v21, v50, v27
    v_fmac_f32 v63, v50, v51
    v_cvt_pk_bf16_f32 v24, v20, v21
    v_min_u32 v24, -2, v24
    v_min_u32 v62, -2, v62
    v_min_u32 v63, -2, v63
    v_mov_b32_dpp v25, v24 quad_perm:[1,1,1,1] row_mask:0xf bank_mask:0xf
    v_mov_b32_dpp v26, v24 quad_perm:[2,2,2,2] row_mask:0xf bank_mask:0xf
    v_mov_b32_dpp v27, v24 quad_perm:[3,3,3,3] row_mask:0xf bank_mask:0xf
    s_mov_b32 exec_lo, 0x11111111
    s_mov_b32 exec_hi, 0x11111111
    buffer_store_dwordx4 v[24:27], v60, s[40:43], s66 offen sc1
    s_mov_b64 exec, 1
    buffer_store_dwordx2 v[62:63], v3, s[40:43], s67 offen sc1
    s_mov_b64 exec, -1
    s_nop 1
L_fB_skip:
    s_waitcnt lgkmcnt(0)
    v_mov_b32 v20, 0
    v_mov_b32 v21, 0
    v_mov_b32 v22, 0
    v_mov_b32 v23, 0
    v_mov_b32 v24, 0
    v_mov_b32 v25, 0
    v_mov_b32 v26, 0
    v_mov_b32 v27, 0
    v_mov_b32 v28, 0
    v_mov_b32 v29, 0
    v_mov_b32 v30, 0
    v_mov_b32 v31, 0
    v_mov_b32 v32, 0
    v_mov_b32 v33, 0
    v_mov_b32 v34, 0
    v_mov_b32 v35, 0
    v_mov_b32 v36, 0xff61b1e6
    v_mul_f32 v38, s58, v36
    v_mov_b32 v40, 0
    v_mov_b32 v37, 0xff61b1e6
    v_mul_f32 v39, s58, v37
    v_mov_b32 v41, 0
    s_cmp_eq_u32 s55, 1
    s_cbranch_scc0 L_Adone
    s_setprio 0
    s_cmp_lt_u32 s3, 4
    s_cbranch_scc1 L_pp3
    s_setprio 1
L_pp3:
L_A:
    s_mov_b64 exec, 1
    ds_add_rtn_u32 v6, v3, v4 offset:48
    s_mov_b32 s70, 0
    s_waitcnt lgkmcnt(0)
    v_readfirstlane_b32 s53, v6
    v_lshlrev_b32 v6, 2, v6
L_Aq:
    s_memrealtime s[44:45]
    ds_read_b32 v5, v6 offset:27904
    s_add_u32 s70, s70, 1
    s_waitcnt lgkmcnt(0)
    v_readfirstlane_b32 s66, v5
    s_cmp_lt_u32 s70, 3200000
    s_cbranch_scc0 L_Aqx
    s_nop 1
    s_cmp_eq_u32 s66, 0
    s_cbranch_scc1 L_Aq
L_Aqx:
    s_mov_b64 exec, -1
    s_sub_u32 s66, s66, 1
    s_min_u32 s53, s53, s77
    s_cmp_lt_u32 s66, 128
    s_cbranch_scc0 L_Adr
    s_lshl_b32 s66, s66, 12
    s_add_u32 s50, s66, s49
    s_mul_i32 s66, s53, s74
    s_lshr_b32 s66, s66, 8
    s_add_u32 s66, s66, s72
    s_sub_u32 s67, s44, s66
    s_cmp_lt_i32 s67, 0
    s_cbranch_scc0 L_pcA2x
    s_mov_b32 s70, 0
L_pcA2:
    s_sleep 1
    s_memrealtime s[44:45]
    s_waitcnt lgkmcnt(0)
    s_add_u32 s70, s70, 1
    s_cmp_lt_u32 s70, 64
    s_cbranch_scc0 L_pcA2x
    s_sub_u32 s67, s44, s66
    s_cmp_lt_i32 s67, 0
    s_cbranch_scc1 L_pcA2
L_pcA2x:
    s_mov_b64 exec, 1
    ds_add_u32 v3, v4 offset:28668
    s_mov_b64 exec, -1
    s_waitcnt vmcnt(7)
    v_mfma_f32_16x16x32_bf16 v[184:187], v[148:151], v[64:67], 0
    buffer_load_dwordx4 v[64:67], v188, s[32:35], s50 offen offset:0 nt
    s_waitcnt vmcnt(7)
    v_mfma_f32_16x16x32_bf16 v[184:187], v[152:155], v[68:71], v[184:187]
    buffer_load_dwordx4 v[68:71], v188, s[32:35], s50 offen offset:128 nt
    s_waitcnt vmcnt(7)
    v_mfma_f32_16x16x32_bf16 v[184:187], v[156:159], v[72:75], v[184:187]
    buffer_load_dwordx4 v[72:75], v188, s[32:35], s50 offen offset:512 nt
    s_waitcnt vmcnt(7)
    v_mfma_f32_16x16x32_bf16 v[184:187], v[160:163], v[76:79], v[184:187]
    buffer_load_dwordx4 v[76:79], v188, s[32:35], s50 offen offset:640 nt
    s_nop 7
    v_add_f32_dpp v46, v185, v184 row_ror:8 row_mask:0xf bank_mask:0x3
    v_add_f32_dpp v46, v186, v187 row_ror:8 row_mask:0xf bank_mask:0xc
    v_mov_b32 v44, v46
    s_nop 0
    v_mov_b32_dpp v44, v46 row_shr:4 row_mask:0x5 bank_mask:0xa
    v_mov_b32_dpp v44, v46 row_shl:4 row_mask:0xa bank_mask:0x5
    v_fma_f32 v45, v44, s58, -v38
    v_cmp_lt_f32 vcc, 0x41000000, v45
    s_cbranch_vccnz L_slowd
L_slowrd:
    v_exp_f32 v45, v45
    s_nop 0
    v_cvt_pk_bf16_f32 v46, v45, v45
    v_and_b32 v45, 0xffff0000, v46
    v_add_f32 v40, v40, v45
    v_and_b32_dpp v168, v46, v164 quad_perm:[0,0,0,0] row_mask:0xf bank_mask:0xf
    v_and_b32_dpp v169, v46, v165 quad_perm:[0,0,0,0] row_mask:0xf bank_mask:0xf
    v_and_b32_dpp v170, v46, v166 quad_perm:[0,0,0,0] row_mask:0xf bank_mask:0xf
    v_and_b32_dpp v171, v46, v167 quad_perm:[0,0,0,0] row_mask:0xf bank_mask:0xf
    v_and_b32_dpp v172, v46, v164 quad_perm:[1,1,1,1] row_mask:0xf bank_mask:0xf
    v_and_b32_dpp v173, v46, v165 quad_perm:[1,1,1,1] row_mask:0xf bank_mask:0xf
    v_and_b32_dpp v174, v46, v166 quad_perm:[1,1,1,1] row_mask:0xf bank_mask:0xf
    v_and_b32_dpp v175, v46, v167 quad_perm:[1,1,1,1] row_mask:0xf bank_mask:0xf
    s_waitcnt vmcnt(7)
    v_mfma_f32_16x16x32_bf16 v[20:23], v[168:171], v[80:83], v[20:23]
    buffer_load_dwordx4 v[80:83], v0, s[36:39], s50 offen offset:0 nt
    v_and_b32_dpp v176, v46, v164 quad_perm:[2,2,2,2] row_mask:0xf bank_mask:0xf
    v_and_b32_dpp v177, v46, v165 quad_perm:[2,2,2,2] row_mask:0xf bank_mask:0xf
    v_and_b32_dpp v178, v46, v166 quad_perm:[2,2,2,2] row_mask:0xf bank_mask:0xf
    v_and_b32_dpp v179, v46, v167 quad_perm:[2,2,2,2] row_mask:0xf bank_mask:0xf
    s_waitcnt vmcnt(7)
    v_mfma_f32_16x16x32_bf16 v[20:23], v[172:175], v[84:87], v[20:23]
    buffer_load_dwordx4 v[84:87], v0, s[36:39], s50 offen offset:1024 nt
    v_and_b32_dpp v180, v46, v164 quad_perm:[3,3,3,3] row_mask:0xf bank_mask:0xf
    v_and_b32_dpp v181, v46, v165 quad_perm:[3,3,3,3] row_mask:0xf bank_mask:0xf
    v_and_b32_dpp v182, v46, v166 quad_perm:[3,3,3,3] row_mask:0xf bank_mask:0xf
    v_and_b32_dpp v183, v46, v167 quad_perm:[3,3,3,3] row_mask:0xf bank_mask:0xf
    s_waitcnt vmcnt(7)
    v_mfma_f32_16x16x32_bf16 v[20:23], v[176:179], v[88:91], v[20:23]
    buffer_load_dwordx4 v[88:91], v0, s[36:39], s50 offen offset:2048 nt
    s_waitcnt vmcnt(7)
    v_mfma_f32_16x16x32_bf16 v[20:23], v[180:183], v[92:95], v[20:23]
    buffer_load_dwordx4 v[92:95], v0, s[36:39], s50 offen offset:3072 nt
    s_branch L_A
L_slowd:
    v_max_f32_dpp v47, v44, v44 quad_perm:[1,0,3,2] row_mask:0xf bank_mask:0xf
    s_nop 1
    v_max_f32_dpp v47, v47, v47 quad_perm:[2,3,0,1] row_mask:0xf bank_mask:0xf
    v_mov_b32 v48, v47
    s_nop 1
    v_permlane16_swap_b32 v47, v48
    v_max_f32 v47, v47, v48
    v_mov_b32 v48, v47
    s_nop 1
    v_permlane32_swap_b32 v47, v48
    v_max_f32 v47, v47, v48
    v_mul_f32 v47, s58, v47
    v_max_f32 v47, v47, v38
    v_sub_f32 v48, v38, v47
    v_exp_f32 v48, v48
    v_mov_b32 v38, v47
    v_fma_f32 v45, v44, s58, -v38
    v_mul_f32 v40, v40, v48
    v_mov_b32_dpp v47, v48 row_newbcast:0 row_mask:0x3 bank_mask:0xf
    v_mov_b32_dpp v47, v48 row_newbcast:8 row_mask:0xc bank_mask:0xf
    v_mul_f32 v20, v20, v47
    v_mul_f32 v21, v21, v47
    v_mul_f32 v22, v22, v47
    v_mul_f32 v23, v23, v47
    s_branch L_slowrd
L_slowe:
    v_max_f32_dpp v47, v44, v44 quad_perm:[1,0,3,2] row_mask:0xf bank_mask:0xf
    s_nop 1
    v_max_f32_dpp v47, v47, v47 quad_perm:[2,3,0,1] row_mask:0xf bank_mask:0xf
    v_mov_b32 v48, v47
    s_nop 1
    v_permlane16_swap_b32 v47, v48
    v_max_f32 v47, v47, v48
    v_mov_b32 v48, v47
    s_nop 1
    v_permlane32_swap_b32 v47, v48
    v_max_f32 v47, v47, v48
    v_mul_f32 v47, s58, v47
    v_max_f32 v47, v47, v38
    v_sub_f32 v48, v38, v47
    v_exp_f32 v48, v48
    v_mov_b32 v38, v47
    v_fma_f32 v45, v44, s58, -v38
    v_mul_f32 v40, v40, v48
    v_mov_b32_dpp v47, v48 row_newbcast:0 row_mask:0x3 bank_mask:0xf
    v_mov_b32_dpp v47, v48 row_newbcast:8 row_mask:0xc bank_mask:0xf
    v_mul_f32 v20, v20, v47
    v_mul_f32 v21, v21, v47
    v_mul_f32 v22, v22, v47
    v_mul_f32 v23, v23, v47
    s_branch L_slowre
L_Adr:
    s_waitcnt vmcnt(7)
    v_mfma_f32_16x16x32_bf16 v[184:187], v[148:151], v[64:67], 0
    s_waitcnt vmcnt(6)
    v_mfma_f32_16x16x32_bf16 v[184:187], v[152:155], v[68:71], v[184:187]
    s_waitcnt vmcnt(5)
    v_mfma_f32_16x16x32_bf16 v[184:187], v[156:159], v[72:75], v[184:187]
    s_waitcnt vmcnt(4)
    v_mfma_f32_16x16x32_bf16 v[184:187], v[160:163], v[76:79], v[184:187]
    s_nop 7
    v_add_f32_dpp v46, v185, v184 row_ror:8 row_mask:0xf bank_mask:0x3
    v_add_f32_dpp v46, v186, v187 row_ror:8 row_mask:0xf bank_mask:0xc
    v_mov_b32 v44, v46
    s_nop 0
    v_mov_b32_dpp v44, v46 row_shr:4 row_mask:0x5 bank_mask:0xa
    v_mov_b32_dpp v44, v46 row_shl:4 row_mask:0xa bank_mask:0x5
    v_fma_f32 v45, v44, s58, -v38
    v_cmp_lt_f32 vcc, 0x41000000, v45
    s_cbranch_vccnz L_slowe
L_slowre:
    v_exp_f32 v45, v45
    s_nop 0
    v_cvt_pk_bf16_f32 v46, v45, v45
    v_and_b32 v45, 0xffff0000, v46
    v_add_f32 v40, v40, v45
    v_and_b32_dpp v168, v46, v164 quad_perm:[0,0,0,0] row_mask:0xf bank_mask:0xf
    v_and_b32_dpp v169, v46, v165 quad_perm:[0,0,0,0] row_mask:0xf bank_mask:0xf
    v_and_b32_dpp v170, v46, v166 quad_perm:[0,0,0,0] row_mask:0xf bank_mask:0xf
    v_and_b32_dpp v171, v46, v167 quad_perm:[0,0,0,0] row_mask:0xf bank_mask:0xf
    v_and_b32_dpp v172, v46, v164 quad_perm:[1,1,1,1] row_mask:0xf bank_mask:0xf
    v_and_b32_dpp v173, v46, v165 quad_perm:[1,1,1,1] row_mask:0xf bank_mask:0xf
    v_and_b32_dpp v174, v46, v166 quad_perm:[1,1,1,1] row_mask:0xf bank_mask:0xf
    v_and_b32_dpp v175, v46, v167 quad_perm:[1,1,1,1] row_mask:0xf bank_mask:0xf
    s_waitcnt vmcnt(3)
    v_mfma_f32_16x16x32_bf16 v[20:23], v[168:171], v[80:83], v[20:23]
    v_and_b32_dpp v176, v46, v164 quad_perm:[2,2,2,2] row_mask:0xf bank_mask:0xf
    v_and_b32_dpp v177, v46, v165 quad_perm:[2,2,2,2] row_mask:0xf bank_mask:0xf
    v_and_b32_dpp v178, v46, v166 quad_perm:[2,2,2,2] row_mask:0xf bank_mask:0xf
    v_and_b32_dpp v179, v46, v167 quad_perm:[2,2,2,2] row_mask:0xf bank_mask:0xf
    s_waitcnt vmcnt(2)
    v_mfma_f32_16x16x32_bf16 v[20:23], v[172:175], v[84:87], v[20:23]
    v_and_b32_dpp v180, v46, v164 quad_perm:[3,3,3,3] row_mask:0xf bank_mask:0xf
    v_and_b32_dpp v181, v46, v165 quad_perm:[3,3,3,3] row_mask:0xf bank_mask:0xf
    v_and_b32_dpp v182, v46, v166 quad_perm:[3,3,3,3] row_mask:0xf bank_mask:0xf
    v_and_b32_dpp v183, v46, v167 quad_perm:[3,3,3,3] row_mask:0xf bank_mask:0xf
    s_waitcnt vmcnt(1)
    v_mfma_f32_16x16x32_bf16 v[20:23], v[176:179], v[88:91], v[20:23]
    s_waitcnt vmcnt(0)
    v_mfma_f32_16x16x32_bf16 v[20:23], v[180:183], v[92:95], v[20:23]
    s_nop 3
L_Adone:
    v_add_f32_dpp v39, v40, v40 quad_perm:[1,0,3,2] row_mask:0xf bank_mask:0xf
    s_lshl_b32 s66, s3, 10
    v_add_u32 v52, s66, v0
    v_add_f32_dpp v39, v39, v39 quad_perm:[2,3,0,1] row_mask:0xf bank_mask:0xf
    v_mov_b32 v41, v39
    s_lshl_b32 s66, s3, 3
    v_lshl_add_u32 v53, v1, 3, s66
    v_permlane16_swap_b32 v39, v41
    v_add_f32 v39, v39, v41
    v_mov_b32 v41, v39
    ds_write_b128 v52, v[20:23] offset:5120
    v_lshrrev_b32 v61, 5, v1
    v_permlane32_swap_b32 v39, v41
    v_add_f32 v39, v39, v41
    v_lshlrev_b32 v60, 6, v61
    s_mov_b64 exec, 0x101
    ds_write_b64 v53, v[38:39] offset:320
    s_mov_b64 exec, 1
    ds_add_rtn_u32 v6, v3, v4 offset:8
    s_mov_b64 exec, -1
    ds_read_b128 v[44:47], v60 offset:320
    ds_read_b128 v[48:51], v60 offset:336
    ds_read_b128 v[64:67], v0 offset:5120
    ds_read_b128 v[68:71], v0 offset:6144
    ds_read_b128 v[72:75], v0 offset:7168
    ds_read_b128 v[76:79], v0 offset:8192
    s_and_b32 s66, s60, 15
    s_lshl_b32 s66, s66, 13
    s_lshr_b32 s68, s60, 4
    s_lshl_b32 s68, s68, 9
    s_add_u32 s66, s66, s68
    s_lshl_b32 s68, s59, 6
    s_add_u32 s66, s66, s68
    s_add_u32 s66, s66, 0x50000
    s_and_b32 s67, s60, 15
    s_mul_i32 s67, s67, 512
    s_lshr_b32 s68, s60, 4
    s_lshl_b32 s68, s68, 6
    s_add_u32 s67, s67, s68
    s_lshl_b32 s68, s59, 3
    s_add_u32 s67, s67, s68
    s_add_u32 s67, s67, 0x70000
    v_bfe_u32 v60, v1, 2, 2
    v_lshlrev_b32 v60, 10, v60
    v_lshl_add_u32 v60, v61, 12, v60
    v_and_b32 v62, 0x30, v0
    v_add_u32 v60, v60, v62
    v_mul_u32_u24 v61, 256, v61
    s_waitcnt lgkmcnt(6)
    v_readfirstlane_b32 s68, v6
    s_waitcnt lgkmcnt(4)
    v_max3_f32 v62, v44, v46, v48
    v_max_f32 v62, v62, v50
    s_cmp_eq_u32 s68, 3
    s_cbranch_scc0 L_fin
    v_sub_f32 v44, v44, v62
    v_sub_f32 v46, v46, v62
    v_sub_f32 v48, v48, v62
    v_sub_f32 v50, v50, v62
    v_exp_f32 v44, v44
    v_exp_f32 v46, v46
    v_exp_f32 v48, v48
    v_exp_f32 v50, v50
    s_waitcnt lgkmcnt(0)
    v_mul_f32 v64, v44, v64
    v_mul_f32 v65, v44, v65
    v_mul_f32 v66, v44, v66
    v_mul_f32 v67, v44, v67
    v_fmac_f32 v64, v46, v68
    v_fmac_f32 v65, v46, v69
    v_fmac_f32 v66, v46, v70
    v_fmac_f32 v67, v46, v71
    v_fmac_f32 v64, v48, v72
    v_fmac_f32 v65, v48, v73
    v_fmac_f32 v66, v48, v74
    v_fmac_f32 v67, v48, v75
    v_fmac_f32 v64, v50, v76
    v_fmac_f32 v65, v50, v77
    v_fmac_f32 v66, v50, v78
    v_fmac_f32 v67, v50, v79
    v_cvt_pk_bf16_f32 v68, v64, v65
    v_cvt_pk_bf16_f32 v69, v66, v67
    v_min_u32 v70, -2, v68
    v_min_u32 v71, -2, v69
    v_min_u32 v68, -2, v68
    v_min_u32 v69, -2, v69
    v_mul_f32 v63, v44, v45
    v_fmac_f32 v63, v46, v47
    v_permlane16_swap_b32 v68, v70
    v_permlane16_swap_b32 v69, v71
    s_mov_b32 exec_lo, 0xffff
    s_mov_b32 exec_hi, 0xffff
    buffer_store_dwordx4 v[68:71], v60, s[40:43], s66 offen sc1
    v_fmac_f32 v63, v48, v49
    v_fmac_f32 v63, v50, v51
    v_min_u32 v62, -2, v62
    v_min_u32 v63, -2, v63
    s_mov_b32 exec_lo, 1
    s_mov_b32 exec_hi, 1
    buffer_store_dwordx2 v[62:63], v61, s[40:43], s67 offen sc1
    s_mov_b64 exec, -1
    s_cmp_lt_u32 s3, 4
    s_cbranch_scc1 L_fin
.p2align 12
L_idle:
    s_sub_u32 s52, s3, 4
    s_mul_i32 s66, s59, 4
    s_add_u32 s64, s60, s66
    s_and_b32 s64, s64, 31
    s_and_b32 s66, s64, 1
    s_lshl_b32 s66, s66, 1
    s_lshr_b32 s67, s52, 1
    s_add_u32 s30, s66, s67
    s_and_b32 s31, s52, 1
    s_lshr_b32 s63, s64, 1
    s_mov_b32 s62, 1
    s_cmp_lt_u32 s64, 18
    s_cbranch_scc1 L_rl
    s_sub_u32 s63, s63, 5
    s_mov_b32 s62, 2
    s_cmp_lt_u32 s64, 28
    s_cbranch_scc1 L_rl
    s_sub_u32 s63, s64, 28
    s_mov_b32 s62, 3
    s_mov_b32 s30, s52
    s_mov_b32 s31, 1
L_rl:
    s_lshl_b32 s66, s59, 2
    s_add_u32 s30, s30, s66
    s_cmp_eq_u32 s62, 1
    s_cselect_b32 s72, s12, s22
    s_cselect_b32 s73, s13, s23
    s_mov_b32 s74, 4718592
    s_mov_b32 s75, 0x20000
    s_cselect_b32 s66, 0, 1152
    s_lshl_b32 s67, s63, 7
    s_add_u32 s53, s66, s67
    s_lshl_b32 s66, s30, 1
    s_add_u32 s66, s66, s31
    s_mul_i32 s66, s66, 73728
    s_add_u32 s65, s66, s67
    s_add_u32 s71, s65, 4608
    s_sub_u32 s48, s65, 73728
    s_sub_u32 s49, s65, 69120
    s_mov_b32 s76, 0x05040100
    s_mov_b32 s77, 0x07060302
    s_mov_b32 s44, s24
    s_mov_b32 s45, s25
    s_mov_b32 s46, 4608
    s_mov_b32 s47, 0x20000
    v_lshrrev_b32 v46, 5, v1
    v_bfe_u32 v47, v1, 3, 1
    v_bfe_u32 v48, v1, 4, 1
    v_and_b32 v49, 7, v1
    v_mul_u32_u24 v36, 2304, v46
    v_lshl_add_u32 v36, v49, 4, v36
    v_lshl_add_u32 v36, v47, 3, v36
    v_lshl_add_u32 v36, v48, 2, v36
    v_lshlrev_b32 v37, 3, v1
    s_lshl_b32 s66, s52, 9
    v_add_u32 v51, s66, v37
    v_lshrrev_b32 v50, 4, v1
    v_lshl_add_u32 v7, v47, 2, v50
    v_mul_u32_u24 v7, 9216, v7
    v_lshl_add_u32 v7, v49, 4, v7
    v_lshlrev_b32 v50, 4, v50
    v_mov_b32 v64, 0
    v_mov_b32 v65, 0
    v_mov_b32 v66, 0
    v_mov_b32 v67, 0
    v_mov_b32 v68, 0
    v_mov_b32 v69, 0
    v_mov_b32 v70, 0
    v_mov_b32 v71, 0
    v_mov_b32 v72, 0
    v_mov_b32 v73, 0
    v_mov_b32 v74, 0
    v_mov_b32 v75, 0
    v_mov_b32 v76, 0
    v_mov_b32 v77, 0
    v_mov_b32 v78, 0
    v_mov_b32 v79, 0
    s_cmp_eq_u32 s62, 3
    s_cbranch_scc0 L_cB2
    buffer_load_dwordx4 v[160:163], v7, s[72:75], s48 offen offset:0 nt
    buffer_load_dwordx4 v[164:167], v7, s[72:75], s48 offen offset:1152 nt
    buffer_load_dwordx4 v[168:171], v7, s[72:75], s48 offen offset:2304 nt
    buffer_load_dwordx4 v[172:175], v7, s[72:75], s48 offen offset:3456 nt
    buffer_load_dwordx4 v[176:179], v7, s[72:75], s49 offen offset:0 nt
    buffer_load_dwordx4 v[180:183], v7, s[72:75], s49 offen offset:1152 nt
    buffer_load_dwordx4 v[184:187], v7, s[72:75], s49 offen offset:2304 nt
    buffer_load_dwordx4 v[188:191], v7, s[72:75], s49 offen offset:3456 nt
    s_mov_b32 vcc_lo, 0x00ff00ff
    s_mov_b32 vcc_hi, 0x00ff00ff
    s_waitcnt vmcnt(6)
    v_cndmask_b32_dpp v80, v162, v160, vcc row_ror:8 row_mask:0xf bank_mask:0xf
    v_cndmask_b32_dpp v81, v163, v161, vcc row_ror:8 row_mask:0xf bank_mask:0xf
    v_cndmask_b32_dpp v82, v166, v164, vcc row_ror:8 row_mask:0xf bank_mask:0xf
    v_cndmask_b32_dpp v83, v167, v165, vcc row_ror:8 row_mask:0xf bank_mask:0xf
    v_mov_b32_dpp v162, v160 row_ror:8 row_mask:0xf bank_mask:0x3
    v_mov_b32_dpp v163, v161 row_ror:8 row_mask:0xf bank_mask:0x3
    v_mov_b32_dpp v166, v164 row_ror:8 row_mask:0xf bank_mask:0x3
    v_mov_b32_dpp v167, v165 row_ror:8 row_mask:0xf bank_mask:0x3
    v_perm_b32 v192, v82, v80, s76
    v_perm_b32 v200, v82, v80, s77
    v_perm_b32 v208, v83, v81, s76
    v_perm_b32 v216, v83, v81, s77
    v_perm_b32 v196, v166, v162, s76
    v_perm_b32 v204, v166, v162, s77
    v_perm_b32 v212, v167, v163, s76
    v_perm_b32 v220, v167, v163, s77
    s_waitcnt vmcnt(4)
    v_cndmask_b32_dpp v80, v170, v168, vcc row_ror:8 row_mask:0xf bank_mask:0xf
    v_cndmask_b32_dpp v81, v171, v169, vcc row_ror:8 row_mask:0xf bank_mask:0xf
    v_cndmask_b32_dpp v82, v174, v172, vcc row_ror:8 row_mask:0xf bank_mask:0xf
    v_cndmask_b32_dpp v83, v175, v173, vcc row_ror:8 row_mask:0xf bank_mask:0xf
    v_mov_b32_dpp v170, v168 row_ror:8 row_mask:0xf bank_mask:0x3
    v_mov_b32_dpp v171, v169 row_ror:8 row_mask:0xf bank_mask:0x3
    v_mov_b32_dpp v174, v172 row_ror:8 row_mask:0xf bank_mask:0x3
    v_mov_b32_dpp v175, v173 row_ror:8 row_mask:0xf bank_mask:0x3
    v_perm_b32 v193, v82, v80, s76
    v_perm_b32 v201, v82, v80, s77
    v_perm_b32 v209, v83, v81, s76
    v_perm_b32 v217, v83, v81, s77
    v_perm_b32 v197, v174, v170, s76
    v_perm_b32 v205, v174, v170, s77
    v_perm_b32 v213, v175, v171, s76
    v_perm_b32 v221, v175, v171, s77
    s_waitcnt vmcnt(2)
    v_cndmask_b32_dpp v80, v178, v176, vcc row_ror:8 row_mask:0xf bank_mask:0xf
    v_cndmask_b32_dpp v81, v179, v177, vcc row_ror:8 row_mask:0xf bank_mask:0xf
    v_cndmask_b32_dpp v82, v182, v180, vcc row_ror:8 row_mask:0xf bank_mask:0xf
    v_cndmask_b32_dpp v83, v183, v181, vcc row_ror:8 row_mask:0xf bank_mask:0xf
    v_mov_b32_dpp v178, v176 row_ror:8 row_mask:0xf bank_mask:0x3
    v_mov_b32_dpp v179, v177 row_ror:8 row_mask:0xf bank_mask:0x3
    v_mov_b32_dpp v182, v180 row_ror:8 row_mask:0xf bank_mask:0x3
    v_mov_b32_dpp v183, v181 row_ror:8 row_mask:0xf bank_mask:0x3
    v_perm_b32 v194, v82, v80, s76
    v_perm_b32 v202, v82, v80, s77
    v_perm_b32 v210, v83, v81, s76
    v_perm_b32 v218, v83, v81, s77
    v_perm_b32 v198, v182, v178, s76
    v_perm_b32 v206, v182, v178, s77
    v_perm_b32 v214, v183, v179, s76
    v_perm_b32 v222, v183, v179, s77
    s_waitcnt vmcnt(0)
    v_cndmask_b32_dpp v80, v186, v184, vcc row_ror:8 row_mask:0xf bank_mask:0xf
    v_cndmask_b32_dpp v81, v187, v185, vcc row_ror:8 row_mask:0xf bank_mask:0xf
    v_cndmask_b32_dpp v82, v190, v188, vcc row_ror:8 row_mask:0xf bank_mask:0xf
    v_cndmask_b32_dpp v83, v191, v189, vcc row_ror:8 row_mask:0xf bank_mask:0xf
    v_mov_b32_dpp v186, v184 row_ror:8 row_mask:0xf bank_mask:0x3
    v_mov_b32_dpp v187, v185 row_ror:8 row_mask:0xf bank_mask:0x3
    v_mov_b32_dpp v190, v188 row_ror:8 row_mask:0xf bank_mask:0x3
    v_mov_b32_dpp v191, v189 row_ror:8 row_mask:0xf bank_mask:0x3
    v_perm_b32 v195, v82, v80, s76
    v_perm_b32 v203, v82, v80, s77
    v_perm_b32 v211, v83, v81, s76
    v_perm_b32 v219, v83, v81, s77
    v_perm_b32 v199, v190, v186, s76
    v_perm_b32 v207, v190, v186, s77
    v_perm_b32 v215, v191, v187, s76
    v_perm_b32 v223, v191, v187, s77
L_cB2:
    s_cmp_eq_u32 s52, 3
    s_cbranch_scc0 L_fx
    v_lshlrev_b32 v228, 2, v1
    s_mov_b32 s80, 1
    s_mov_b32 s70, 0
    s_branch L_fae
L_fa:
    s_sleep 8
L_fae:
    ds_read_b32 v6, v3 offset:12
    s_waitcnt lgkmcnt(0)
    v_readfirstlane_b32 s66, v6
    s_nop 3
    s_add_u32 s70, s70, 1
    s_cmp_lt_u32 s70, 3200000
    s_cbranch_scc0 L_fax
    s_cmp_lt_u32 s66, 1
    s_cbranch_scc1 L_fa
L_fax:
    s_sub_u32 s68, s27, 4
    s_mov_b32 s70, 0
    s_branch L_fbe
L_fb:
    s_sleep 1
L_fbe:
    ds_read_b32 v6, v3 offset:0
    s_waitcnt lgkmcnt(0)
    v_readfirstlane_b32 s66, v6
    s_nop 3
    s_add_u32 s70, s70, 1
    s_cmp_lt_u32 s70, 3200000
    s_cbranch_scc0 L_fbx
    s_cmp_lt_u32 s66, s68
    s_cbranch_scc1 L_fb
L_fbx:
    s_mov_b64 exec, 1
    v_mov_b32 v224, 1
    buffer_atomic_add v224, v2, s[40:43], 0 offen sc0
    v_mov_b32 v225, 1
    buffer_atomic_add v225, v2, s[40:43], 0 offen sc0
    v_mov_b32 v226, 1
    buffer_atomic_add v226, v2, s[40:43], 0 offen sc0
    v_mov_b32 v227, 1
    buffer_atomic_add v227, v2, s[40:43], 0 offen sc0
L_ft:
    s_mov_b64 exec, 0x1f
    s_waitcnt vmcnt(3)
    v_readfirstlane_b32 s66, v224
    s_nop 3
    s_add_u32 s67, s66, 1
    v_add_u32 v229, s67, v1
    s_cmp_lt_u32 s66, 127
    s_cbranch_scc0 L_fe
    s_mov_b64 exec, 0x1
    ds_write_b32 v228, v229 offset:27904
    s_mov_b64 exec, 0x1f
    v_add_u32 v228, 4, v228
    s_mov_b64 exec, 1
    s_mov_b32 s70, 0
    s_branch L_fw0e
L_fw0:
    s_sleep 1
L_fw0e:
    ds_read_b32 v6, v3 offset:28668
    s_waitcnt lgkmcnt(0)
    v_readfirstlane_b32 s66, v6
    s_nop 3
    s_add_u32 s70, s70, 1
    s_cmp_lt_u32 s70, 3200000
    s_cbranch_scc0 L_fw0x
    s_cmp_lt_u32 s66, s80
    s_cbranch_scc1 L_fw0
L_fw0x:
    s_add_u32 s80, s80, 1
    v_mov_b32 v224, 1
    buffer_atomic_add v224, v2, s[40:43], 0 offen sc0
    s_mov_b64 exec, 0x1f
    s_waitcnt vmcnt(3)
    v_readfirstlane_b32 s66, v225
    s_nop 3
    s_add_u32 s67, s66, 1
    v_add_u32 v229, s67, v1
    s_cmp_lt_u32 s66, 127
    s_cbranch_scc0 L_fe
    s_mov_b64 exec, 0x1
    ds_write_b32 v228, v229 offset:27904
    s_mov_b64 exec, 0x1f
    v_add_u32 v228, 4, v228
    s_mov_b64 exec, 1
    s_mov_b32 s70, 0
    s_branch L_fw1e
L_fw1:
    s_sleep 1
L_fw1e:
    ds_read_b32 v6, v3 offset:28668
    s_waitcnt lgkmcnt(0)
    v_readfirstlane_b32 s66, v6
    s_nop 3
    s_add_u32 s70, s70, 1
    s_cmp_lt_u32 s70, 3200000
    s_cbranch_scc0 L_fw1x
    s_cmp_lt_u32 s66, s80
    s_cbranch_scc1 L_fw1
L_fw1x:
    s_add_u32 s80, s80, 1
    v_mov_b32 v225, 1
    buffer_atomic_add v225, v2, s[40:43], 0 offen sc0
    s_mov_b64 exec, 0x1f
    s_waitcnt vmcnt(3)
    v_readfirstlane_b32 s66, v226
    s_nop 3
    s_add_u32 s67, s66, 1
    v_add_u32 v229, s67, v1
    s_cmp_lt_u32 s66, 127
    s_cbranch_scc0 L_fe
    s_mov_b64 exec, 0x1
    ds_write_b32 v228, v229 offset:27904
    s_mov_b64 exec, 0x1f
    v_add_u32 v228, 4, v228
    s_mov_b64 exec, 1
    s_mov_b32 s70, 0
    s_branch L_fw2e
L_fw2:
    s_sleep 1
L_fw2e:
    ds_read_b32 v6, v3 offset:28668
    s_waitcnt lgkmcnt(0)
    v_readfirstlane_b32 s66, v6
    s_nop 3
    s_add_u32 s70, s70, 1
    s_cmp_lt_u32 s70, 3200000
    s_cbranch_scc0 L_fw2x
    s_cmp_lt_u32 s66, s80
    s_cbranch_scc1 L_fw2
L_fw2x:
    s_add_u32 s80, s80, 1
    v_mov_b32 v226, 1
    buffer_atomic_add v226, v2, s[40:43], 0 offen sc0
    s_mov_b64 exec, 0x1f
    s_waitcnt vmcnt(3)
    v_readfirstlane_b32 s66, v227
    s_nop 3
    s_add_u32 s67, s66, 1
    v_add_u32 v229, s67, v1
    s_cmp_lt_u32 s66, 127
    s_cbranch_scc0 L_fe
    s_mov_b64 exec, 0x1
    ds_write_b32 v228, v229 offset:27904
    s_mov_b64 exec, 0x1f
    v_add_u32 v228, 4, v228
    s_mov_b64 exec, 1
    s_mov_b32 s70, 0
    s_branch L_fw3e
L_fw3:
    s_sleep 1
L_fw3e:
    ds_read_b32 v6, v3 offset:28668
    s_waitcnt lgkmcnt(0)
    v_readfirstlane_b32 s66, v6
    s_nop 3
    s_add_u32 s70, s70, 1
    s_cmp_lt_u32 s70, 3200000
    s_cbranch_scc0 L_fw3x
    s_cmp_lt_u32 s66, s80
    s_cbranch_scc1 L_fw3
L_fw3x:
    s_add_u32 s80, s80, 1
    v_mov_b32 v227, 1
    buffer_atomic_add v227, v2, s[40:43], 0 offen sc0
    s_branch L_ft
L_fe:
    ds_write_b32 v228, v229 offset:27904
    s_mov_b64 exec, -1
    s_waitcnt vmcnt(0)
L_fx:
    s_cmp_eq_u32 s62, 1
    s_cbranch_scc1 L_cA
    v_lshl_add_u32 v38, v47, 8, v50
    v_and_b32 v49, 3, v1
    v_lshl_add_u32 v38, v49, 6, v38
    s_lshl_b32 s66, s30, 1
    s_add_u32 s66, s66, s31
    s_lshl_b32 s66, s66, 10
    s_add_u32 s69, s66, 0x30000
    s_add_u32 s55, s69, 512
    s_sub_u32 s54, s69, 1024
    s_sub_u32 s50, s69, 512
    v_lshlrev_b32 v39, 5, v46
    s_mul_i32 s67, s30, 256
    s_add_u32 s67, s67, 0x40000
    s_lshl_b32 s68, s52, 2
    s_lshr_b32 s68, 0x4321, s68
    s_and_b32 s68, s68, 15
    s_mov_b32 s70, 0
    s_branch L_idBe
L_idB:
    s_sleep 1
L_idBe:
    ds_read_b32 v6, v3 offset:8
    s_waitcnt lgkmcnt(0)
    v_readfirstlane_b32 s66, v6
    s_nop 3
    s_add_u32 s70, s70, 1
    s_cmp_lt_u32 s70, 3200000
    s_cbranch_scc0 L_idBx
    s_cmp_lt_u32 s66, s68
    s_cbranch_scc1 L_idB
L_idBx:
    s_cmp_eq_u32 s62, 3
    s_cbranch_scc0 L_cB3
    buffer_load_dwordx4 v[232:235], v38, s[40:43], s54 offen sc1
    buffer_load_dwordx4 v[236:239], v38, s[40:43], s50 offen sc1
L_cB3:
    buffer_load_dwordx4 v[240:243], v39, s[40:43], s67 offen offset:0 sc1
    buffer_load_dwordx4 v[244:247], v39, s[40:43], s67 offen offset:16 sc1
    buffer_load_dwordx4 v[224:227], v38, s[40:43], s69 offen sc1
    buffer_load_dwordx4 v[228:231], v38, s[40:43], s55 offen sc1
    buffer_load_dwordx4 v[96:99], v7, s[72:75], s65 offen offset:0 nt
    buffer_load_dwordx4 v[100:103], v7, s[72:75], s65 offen offset:1152 nt
    buffer_load_dwordx4 v[104:107], v7, s[72:75], s65 offen offset:2304 nt
    buffer_load_dwordx4 v[108:111], v7, s[72:75], s65 offen offset:3456 nt
    buffer_load_dwordx4 v[112:115], v7, s[72:75], s71 offen offset:0 nt
    buffer_load_dwordx4 v[116:119], v7, s[72:75], s71 offen offset:1152 nt
    buffer_load_dwordx4 v[120:123], v7, s[72:75], s71 offen offset:2304 nt
    buffer_load_dwordx4 v[124:127], v7, s[72:75], s71 offen offset:3456 nt
    s_mov_b32 vcc_lo, 0x00ff00ff
    s_mov_b32 vcc_hi, 0x00ff00ff
    s_waitcnt vmcnt(6)
    v_cndmask_b32_dpp v80, v98, v96, vcc row_ror:8 row_mask:0xf bank_mask:0xf
    v_cndmask_b32_dpp v81, v99, v97, vcc row_ror:8 row_mask:0xf bank_mask:0xf
    v_cndmask_b32_dpp v82, v102, v100, vcc row_ror:8 row_mask:0xf bank_mask:0xf
    v_cndmask_b32_dpp v83, v103, v101, vcc row_ror:8 row_mask:0xf bank_mask:0xf
    v_mov_b32_dpp v98, v96 row_ror:8 row_mask:0xf bank_mask:0x3
    v_mov_b32_dpp v99, v97 row_ror:8 row_mask:0xf bank_mask:0x3
    v_mov_b32_dpp v102, v100 row_ror:8 row_mask:0xf bank_mask:0x3
    v_mov_b32_dpp v103, v101 row_ror:8 row_mask:0xf bank_mask:0x3
    v_perm_b32 v128, v82, v80, s76
    v_perm_b32 v136, v82, v80, s77
    v_perm_b32 v144, v83, v81, s76
    v_perm_b32 v152, v83, v81, s77
    v_perm_b32 v132, v102, v98, s76
    v_perm_b32 v140, v102, v98, s77
    v_perm_b32 v148, v103, v99, s76
    v_perm_b32 v156, v103, v99, s77
    s_waitcnt vmcnt(4)
    v_cndmask_b32_dpp v80, v106, v104, vcc row_ror:8 row_mask:0xf bank_mask:0xf
    v_cndmask_b32_dpp v81, v107, v105, vcc row_ror:8 row_mask:0xf bank_mask:0xf
    v_cndmask_b32_dpp v82, v110, v108, vcc row_ror:8 row_mask:0xf bank_mask:0xf
    v_cndmask_b32_dpp v83, v111, v109, vcc row_ror:8 row_mask:0xf bank_mask:0xf
    v_mov_b32_dpp v106, v104 row_ror:8 row_mask:0xf bank_mask:0x3
    v_mov_b32_dpp v107, v105 row_ror:8 row_mask:0xf bank_mask:0x3
    v_mov_b32_dpp v110, v108 row_ror:8 row_mask:0xf bank_mask:0x3
    v_mov_b32_dpp v111, v109 row_ror:8 row_mask:0xf bank_mask:0x3
    v_perm_b32 v129, v82, v80, s76
    v_perm_b32 v137, v82, v80, s77
    v_perm_b32 v145, v83, v81, s76
    v_perm_b32 v153, v83, v81, s77
    v_perm_b32 v133, v110, v106, s76
    v_perm_b32 v141, v110, v106, s77
    v_perm_b32 v149, v111, v107, s76
    v_perm_b32 v157, v111, v107, s77
    s_waitcnt vmcnt(2)
    v_cndmask_b32_dpp v80, v114, v112, vcc row_ror:8 row_mask:0xf bank_mask:0xf
    v_cndmask_b32_dpp v81, v115, v113, vcc row_ror:8 row_mask:0xf bank_mask:0xf
    v_cndmask_b32_dpp v82, v118, v116, vcc row_ror:8 row_mask:0xf bank_mask:0xf
    v_cndmask_b32_dpp v83, v119, v117, vcc row_ror:8 row_mask:0xf bank_mask:0xf
    v_mov_b32_dpp v114, v112 row_ror:8 row_mask:0xf bank_mask:0x3
    v_mov_b32_dpp v115, v113 row_ror:8 row_mask:0xf bank_mask:0x3
    v_mov_b32_dpp v118, v116 row_ror:8 row_mask:0xf bank_mask:0x3
    v_mov_b32_dpp v119, v117 row_ror:8 row_mask:0xf bank_mask:0x3
    v_perm_b32 v130, v82, v80, s76
    v_perm_b32 v138, v82, v80, s77
    v_perm_b32 v146, v83, v81, s76
    v_perm_b32 v154, v83, v81, s77
    v_perm_b32 v134, v118, v114, s76
    v_perm_b32 v142, v118, v114, s77
    v_perm_b32 v150, v119, v115, s76
    v_perm_b32 v158, v119, v115, s77
    s_waitcnt vmcnt(0)
    v_cndmask_b32_dpp v80, v122, v120, vcc row_ror:8 row_mask:0xf bank_mask:0xf
    v_cndmask_b32_dpp v81, v123, v121, vcc row_ror:8 row_mask:0xf bank_mask:0xf
    v_cndmask_b32_dpp v82, v126, v124, vcc row_ror:8 row_mask:0xf bank_mask:0xf
    v_cndmask_b32_dpp v83, v127, v125, vcc row_ror:8 row_mask:0xf bank_mask:0xf
    v_mov_b32_dpp v122, v120 row_ror:8 row_mask:0xf bank_mask:0x3
    v_mov_b32_dpp v123, v121 row_ror:8 row_mask:0xf bank_mask:0x3
    v_mov_b32_dpp v126, v124 row_ror:8 row_mask:0xf bank_mask:0x3
    v_mov_b32_dpp v127, v125 row_ror:8 row_mask:0xf bank_mask:0x3
    v_perm_b32 v131, v82, v80, s76
    v_perm_b32 v139, v82, v80, s77
    v_perm_b32 v147, v83, v81, s76
    v_perm_b32 v155, v83, v81, s77
    v_perm_b32 v135, v126, v122, s76
    v_perm_b32 v143, v126, v122, s77
    v_perm_b32 v151, v127, v123, s76
    v_perm_b32 v159, v127, v123, s77
    s_mov_b32 s70, 0
    s_cmp_eq_u32 s62, 3
    s_cbranch_scc0 L_chk
L_x0:
    v_max3_u32 v48, v232, v233, v234
    v_max3_u32 v49, v235, v236, v237
    v_max3_u32 v48, v48, v238, v239
    v_max_u32 v48, v48, v49
    v_cmp_eq_u32 vcc, -1, v48
    s_cbranch_vccz L_x1
    s_add_u32 s70, s70, 1
    s_cmp_lt_u32 s70, 200000
    s_cbranch_scc0 L_x1
    buffer_load_dwordx4 v[232:235], v38, s[40:43], s54 offen sc1
    buffer_load_dwordx4 v[236:239], v38, s[40:43], s50 offen sc1
    s_waitcnt vmcnt(0)
    s_branch L_x0
L_x1:
    v_mfma_f32_16x16x32_bf16 v[64:67], v[232:235], v[192:195], v[64:67]
    v_mfma_f32_16x16x32_bf16 v[64:67], v[236:239], v[196:199], v[64:67]
    v_mfma_f32_16x16x32_bf16 v[68:71], v[232:235], v[200:203], v[68:71]
    v_mfma_f32_16x16x32_bf16 v[68:71], v[236:239], v[204:207], v[68:71]
    v_mfma_f32_16x16x32_bf16 v[72:75], v[232:235], v[208:211], v[72:75]
    v_mfma_f32_16x16x32_bf16 v[72:75], v[236:239], v[212:215], v[72:75]
    v_mfma_f32_16x16x32_bf16 v[76:79], v[232:235], v[216:219], v[76:79]
    v_mfma_f32_16x16x32_bf16 v[76:79], v[236:239], v[220:223], v[76:79]
    s_branch L_chk
L_cA:
    v_lshl_add_u32 v38, v47, 9, v50
    v_and_b32 v49, 7, v1
    v_lshl_add_u32 v38, v49, 6, v38
    s_lshl_b32 s66, s30, 1
    s_add_u32 s66, s66, s31
    s_lshl_b32 s66, s66, 11
    s_add_u32 s69, s66, 0x50000
    s_add_u32 s55, s69, 1024
    s_sub_u32 s54, s69, 2048
    s_sub_u32 s50, s69, 1024
    v_lshlrev_b32 v39, 6, v46
    v_lshl_add_u32 v39, v48, 5, v39
    s_mul_i32 s67, s30, 256
    s_add_u32 s67, s67, 0x70000
    s_lshl_b32 s68, s52, 2
    s_lshr_b32 s68, 0x3211, s68
    s_and_b32 s68, s68, 15
    s_mov_b32 s70, 0
    s_branch L_idAe
L_idA:
    s_sleep 1
L_idAe:
    ds_read_b32 v6, v3 offset:8
    s_waitcnt lgkmcnt(0)
    v_readfirstlane_b32 s66, v6
    s_nop 3
    s_add_u32 s70, s70, 1
    s_cmp_lt_u32 s70, 3200000
    s_cbranch_scc0 L_idAx
    s_cmp_lt_u32 s66, s68
    s_cbranch_scc1 L_idA
L_idAx:
    buffer_load_dwordx4 v[96:99], v7, s[72:75], s65 offen offset:0 nt
    buffer_load_dwordx4 v[100:103], v7, s[72:75], s65 offen offset:1152 nt
    buffer_load_dwordx4 v[104:107], v7, s[72:75], s65 offen offset:2304 nt
    buffer_load_dwordx4 v[108:111], v7, s[72:75], s65 offen offset:3456 nt
    buffer_load_dwordx4 v[112:115], v7, s[72:75], s71 offen offset:0 nt
    buffer_load_dwordx4 v[116:119], v7, s[72:75], s71 offen offset:1152 nt
    buffer_load_dwordx4 v[120:123], v7, s[72:75], s71 offen offset:2304 nt
    buffer_load_dwordx4 v[124:127], v7, s[72:75], s71 offen offset:3456 nt
    s_mov_b32 vcc_lo, 0x00ff00ff
    s_mov_b32 vcc_hi, 0x00ff00ff
    s_waitcnt vmcnt(6)
    v_cndmask_b32_dpp v80, v98, v96, vcc row_ror:8 row_mask:0xf bank_mask:0xf
    v_cndmask_b32_dpp v81, v99, v97, vcc row_ror:8 row_mask:0xf bank_mask:0xf
    v_cndmask_b32_dpp v82, v102, v100, vcc row_ror:8 row_mask:0xf bank_mask:0xf
    v_cndmask_b32_dpp v83, v103, v101, vcc row_ror:8 row_mask:0xf bank_mask:0xf
    v_mov_b32_dpp v98, v96 row_ror:8 row_mask:0xf bank_mask:0x3
    v_mov_b32_dpp v99, v97 row_ror:8 row_mask:0xf bank_mask:0x3
    v_mov_b32_dpp v102, v100 row_ror:8 row_mask:0xf bank_mask:0x3
    v_mov_b32_dpp v103, v101 row_ror:8 row_mask:0xf bank_mask:0x3
    v_perm_b32 v128, v82, v80, s76
    v_perm_b32 v136, v82, v80, s77
    v_perm_b32 v144, v83, v81, s76
    v_perm_b32 v152, v83, v81, s77
    v_perm_b32 v132, v102, v98, s76
    v_perm_b32 v140, v102, v98, s77
    v_perm_b32 v148, v103, v99, s76
    v_perm_b32 v156, v103, v99, s77
    s_waitcnt vmcnt(4)
    v_cndmask_b32_dpp v80, v106, v104, vcc row_ror:8 row_mask:0xf bank_mask:0xf
    v_cndmask_b32_dpp v81, v107, v105, vcc row_ror:8 row_mask:0xf bank_mask:0xf
    v_cndmask_b32_dpp v82, v110, v108, vcc row_ror:8 row_mask:0xf bank_mask:0xf
    v_cndmask_b32_dpp v83, v111, v109, vcc row_ror:8 row_mask:0xf bank_mask:0xf
    v_mov_b32_dpp v106, v104 row_ror:8 row_mask:0xf bank_mask:0x3
    v_mov_b32_dpp v107, v105 row_ror:8 row_mask:0xf bank_mask:0x3
    v_mov_b32_dpp v110, v108 row_ror:8 row_mask:0xf bank_mask:0x3
    v_mov_b32_dpp v111, v109 row_ror:8 row_mask:0xf bank_mask:0x3
    v_perm_b32 v129, v82, v80, s76
    v_perm_b32 v137, v82, v80, s77
    v_perm_b32 v145, v83, v81, s76
    v_perm_b32 v153, v83, v81, s77
    v_perm_b32 v133, v110, v106, s76
    v_perm_b32 v141, v110, v106, s77
    v_perm_b32 v149, v111, v107, s76
    v_perm_b32 v157, v111, v107, s77
    s_waitcnt vmcnt(2)
    v_cndmask_b32_dpp v80, v114, v112, vcc row_ror:8 row_mask:0xf bank_mask:0xf
    v_cndmask_b32_dpp v81, v115, v113, vcc row_ror:8 row_mask:0xf bank_mask:0xf
    v_cndmask_b32_dpp v82, v118, v116, vcc row_ror:8 row_mask:0xf bank_mask:0xf
    v_cndmask_b32_dpp v83, v119, v117, vcc row_ror:8 row_mask:0xf bank_mask:0xf
    v_mov_b32_dpp v114, v112 row_ror:8 row_mask:0xf bank_mask:0x3
    v_mov_b32_dpp v115, v113 row_ror:8 row_mask:0xf bank_mask:0x3
    v_mov_b32_dpp v118, v116 row_ror:8 row_mask:0xf bank_mask:0x3
    v_mov_b32_dpp v119, v117 row_ror:8 row_mask:0xf bank_mask:0x3
    v_perm_b32 v130, v82, v80, s76
    v_perm_b32 v138, v82, v80, s77
    v_perm_b32 v146, v83, v81, s76
    v_perm_b32 v154, v83, v81, s77
    v_perm_b32 v134, v118, v114, s76
    v_perm_b32 v142, v118, v114, s77
    v_perm_b32 v150, v119, v115, s76
    v_perm_b32 v158, v119, v115, s77
    s_waitcnt vmcnt(0)
    v_cndmask_b32_dpp v80, v122, v120, vcc row_ror:8 row_mask:0xf bank_mask:0xf
    v_cndmask_b32_dpp v81, v123, v121, vcc row_ror:8 row_mask:0xf bank_mask:0xf
    v_cndmask_b32_dpp v82, v126, v124, vcc row_ror:8 row_mask:0xf bank_mask:0xf
    v_cndmask_b32_dpp v83, v127, v125, vcc row_ror:8 row_mask:0xf bank_mask:0xf
    v_mov_b32_dpp v122, v120 row_ror:8 row_mask:0xf bank_mask:0x3
    v_mov_b32_dpp v123, v121 row_ror:8 row_mask:0xf bank_mask:0x3
    v_mov_b32_dpp v126, v124 row_ror:8 row_mask:0xf bank_mask:0x3
    v_mov_b32_dpp v127, v125 row_ror:8 row_mask:0xf bank_mask:0x3
    v_perm_b32 v131, v82, v80, s76
    v_perm_b32 v139, v82, v80, s77
    v_perm_b32 v147, v83, v81, s76
    v_perm_b32 v155, v83, v81, s77
    v_perm_b32 v135, v126, v122, s76
    v_perm_b32 v143, v126, v122, s77
    v_perm_b32 v151, v127, v123, s76
    v_perm_b32 v159, v127, v123, s77
    s_mov_b64 exec, 1
    ds_add_u32 v3, v4 offset:52
    s_mov_b64 exec, -1
    s_mov_b32 s70, 0
    s_branch L_idDe
L_idD:
    s_sleep 1
L_idDe:
    ds_read_b32 v6, v3 offset:52
    s_waitcnt lgkmcnt(0)
    v_readfirstlane_b32 s66, v6
    s_nop 3
    s_add_u32 s70, s70, 1
    s_cmp_lt_u32 s70, 3200000
    s_cbranch_scc0 L_idDx
    s_cmp_lt_u32 s66, 4
    s_cbranch_scc1 L_idD
L_idDx:
    s_mov_b32 s70, 0
L_pl:
    buffer_load_dwordx4 v[240:243], v39, s[40:43], s67 offen offset:0 sc1
    buffer_load_dwordx4 v[244:247], v39, s[40:43], s67 offen offset:16 sc1
    buffer_load_dwordx4 v[224:227], v38, s[40:43], s69 offen sc1
    buffer_load_dwordx4 v[228:231], v38, s[40:43], s55 offen sc1
    s_mov_b64 exec, -1
L_chk:
    s_waitcnt vmcnt(2)
    v_max3_u32 v48, v240, v241, v242
    v_max3_u32 v49, v243, v244, v245
    v_max3_f32 v52, v240, v242, v244
    v_max_f32 v52, v52, v246
    v_mov_b32 v53, v52
    v_max3_u32 v48, v48, v246, v247
    s_waitcnt vmcnt(1)
    v_permlane16_swap_b32 v52, v53
    v_max3_u32 v49, v49, v224, v225
    v_max3_u32 v48, v48, v226, v227
    v_max_f32 v52, v52, v53
    s_waitcnt vmcnt(0)
    v_max3_u32 v49, v49, v228, v229
    v_max3_u32 v48, v48, v230, v231
    v_max_u32 v48, v48, v49
    v_cmp_eq_u32 vcc, -1, v48
    s_cbranch_vccz L_gok
    s_add_u32 s70, s70, 1
    s_cmp_lt_u32 s70, 200000
    s_cbranch_scc0 L_gok
    s_mov_b64 exec, vcc
    s_branch L_pl
L_gok:
    v_mfma_f32_16x16x32_bf16 v[64:67], v[224:227], v[128:131], v[64:67]
    v_sub_f32 v88, v240, v52
    v_sub_f32 v89, v242, v52
    v_mfma_f32_16x16x32_bf16 v[64:67], v[228:231], v[132:135], v[64:67]
    v_sub_f32 v90, v244, v52
    v_sub_f32 v91, v246, v52
    v_mfma_f32_16x16x32_bf16 v[72:75], v[224:227], v[144:147], v[72:75]
    v_exp_f32 v88, v88
    v_mfma_f32_16x16x32_bf16 v[72:75], v[228:231], v[148:151], v[72:75]
    v_exp_f32 v89, v89
    v_mfma_f32_16x16x32_bf16 v[68:71], v[224:227], v[136:139], v[68:71]
    v_exp_f32 v90, v90
    v_mfma_f32_16x16x32_bf16 v[68:71], v[228:231], v[140:143], v[68:71]
    v_exp_f32 v91, v91
    v_mfma_f32_16x16x32_bf16 v[76:79], v[224:227], v[152:155], v[76:79]
    v_mul_f32 v54, v88, v241
    v_fmac_f32 v54, v89, v243
    v_mfma_f32_16x16x32_bf16 v[76:79], v[228:231], v[156:159], v[76:79]
    v_fmac_f32 v54, v90, v245
    v_fmac_f32 v54, v91, v247
    v_mov_b32 v53, v54
    v_mul_f32 v20, v88, v64
    v_mul_f32 v22, v88, v72
    v_permlane16_swap_b32 v54, v53
    v_fmac_f32 v20, v89, v65
    v_fmac_f32 v22, v89, v73
    v_add_f32 v54, v54, v53
    v_fmac_f32 v20, v90, v66
    v_fmac_f32 v22, v90, v74
    v_rcp_f32 v54, v54
    v_fmac_f32 v20, v91, v67
    v_fmac_f32 v22, v91, v75
    v_mul_f32 v21, v88, v68
    v_mul_f32 v23, v88, v76
    v_permlane16_swap_b32 v20, v22
    v_fmac_f32 v21, v89, v69
    v_fmac_f32 v23, v89, v77
    v_fmac_f32 v21, v90, v70
    v_fmac_f32 v23, v90, v78
    v_fmac_f32 v21, v91, v71
    v_fmac_f32 v23, v91, v79
    v_add_f32 v20, v20, v22
    v_mul_f32 v20, v20, v54
    v_permlane16_swap_b32 v21, v23
    v_add_f32 v21, v21, v23
    v_mul_f32 v21, v21, v54
    ds_write_b64 v51, v[20:21] offset:13312
    s_mov_b64 exec, 1
    ds_add_rtn_u32 v6, v3, v4 offset:28
    s_mov_b64 exec, -1
    ds_read2st64_b64 v[24:27], v37 offset0:26 offset1:27
    ds_read2st64_b64 v[28:31], v37 offset0:28 offset1:29
    s_waitcnt lgkmcnt(2)
    v_readfirstlane_b32 s66, v6
    s_waitcnt lgkmcnt(0)
    v_add_f32 v24, v24, v28
    v_add_f32 v25, v25, v29
    v_add_f32 v26, v26, v30
    v_add_f32 v27, v27, v31
    s_cmp_eq_u32 s66, 3
    s_cbranch_scc0 L_fin
    v_add_f32 v24, v24, v26
    v_add_f32 v25, v25, v27
    v_cvt_pk_bf16_f32 v48, v24, v25
    buffer_atomic_pk_add_bf16 v48, v36, s[44:47], s53 offen
L_fin:
    s_waitcnt vmcnt(0)
L_end:
    s_endpgm
.section .rodata,"a"
.p2align 6
.amdhsa_kernel concat_heads__sliding_block_cached__mha_block_cached__decode_kernel
  .amdhsa_next_free_vgpr 252
  .amdhsa_next_free_sgpr 102
  .amdhsa_accum_offset 252
  .amdhsa_group_segment_fixed_size 0
  .amdhsa_kernarg_size 104
  .amdhsa_user_sgpr_count 2
  .amdhsa_user_sgpr_kernarg_segment_ptr 1
  .amdhsa_system_sgpr_workgroup_id_x 1
.end_amdhsa_kernel
```
